```python
import torch

def _softmax(x, axis=-1):
    return torch.softmax(x, dim=axis)
def _gelu(x):
    return torch.nn.functional.gelu(x, approximate="tanh")
def _silu(x):
    return torch.nn.functional.silu(x)
def _sigmoid(x):
    return torch.sigmoid(x)
def _layernorm(x, axis=-1, eps=1e-5):
    m = x.mean(dim=axis, keepdim=True)
    v = x.var(dim=axis, keepdim=True, unbiased=False)
    return (x - m) / torch.sqrt(v + eps)
def _scatter_add(tgt, idx, src, axis=0):
    return tgt.clone().index_add_(axis, idx, src)
def _segment_sum(src, seg, n):
    out = torch.zeros((n,) + src.shape[1:], dtype=src.dtype)
    return out.index_add_(0, seg, src)
def _pad(x, pw):
    flat = tuple(v for pair in reversed(pw) for v in pair)
    return torch.nn.functional.pad(x, flat)

kernel_name = 'standalone__mixer_s_mlp__prompt'

def setup_inputs():

    _w = (lambda a: (lambda t: t.to(torch.bfloat16) if t.is_floating_point() else t)(torch.as_tensor(a)))
    B, S, D, F = 1, 2048, 512, 1376
    return {
        "x":  _w((lambda *s: torch.randn(*s, dtype=torch.bfloat16) * 0.4)(B, S, D)),
        "w1": _w((lambda *s: torch.randn(*s, dtype=torch.bfloat16) * 3.2)(D, D) * (D ** -0.5)),
        "w2": _w((lambda *s: torch.randn(*s, dtype=torch.bfloat16) * 3.2)(D, D) * (D ** -0.5)),
        "w3": _w((lambda *s: torch.randn(*s, dtype=torch.bfloat16) * 3.2)(D, F) * (D ** -0.5)),
        "w4": _w((lambda *s: torch.randn(*s, dtype=torch.bfloat16) * 0.8)(F, D) * (F ** -0.5)),
    }

def reference(x, w1, w2, w3, w4):
    B, S, D = x.shape
    h = _gelu(_layernorm(x, axis=-1) @ w1)
    c = D // 4
    g0 = _pad(h[:, :, 0*c:1*c], ((0, 0), (1, 0), (0, 0)))[:, :S, :]
    g1 = _pad(h[:, :, 1*c:2*c], ((0, 0), (0, 1), (0, 0)))[:, 1:, :]
    g2 = _pad(h[:, :, 2*c:3*c], ((0, 0), (2, 0), (0, 0)))[:, :S, :]
    g3 = _pad(h[:, :, 3*c:   ], ((0, 0), (0, 2), (0, 0)))[:, 2:, :]
    hs = torch.concatenate([g0, g1, g2, g3], axis=-1) @ w2
    x1 = x + hs
    h2 = _gelu(_layernorm(x1, axis=-1) @ w3) @ w4
    return x1 + h2
```

```asm
; @launch grid=(256,1,1) block=(512,1,1) lds=163840
.amdgcn_target "amdgcn-amd-amdhsa--gfx950"
.text
.globl standalone__mixer_s_mlp__prompt_kernel
.p2align 8
.type standalone__mixer_s_mlp__prompt_kernel,@function
standalone__mixer_s_mlp__prompt_kernel:
CODE_BEGIN:
    s_cmp_ge_u32 s2, 256
    s_cbranch_scc1 Lend
    s_load_dwordx16 s[36:51], s[0:1], 0
    s_memrealtime s[70:71]
    v_lshrrev_b32 v2, 6, v0
    v_and_b32 v1, 63, v0
    s_and_b32 s59, s2, 7
    v_readfirstlane_b32 s64, v2
    s_lshr_b32 s60, s2, 3
    s_and_b32 s60, s60, 1
    s_lshl_b32 s52, s59, 1
    s_add_u32 s52, s52, s60
    s_lshr_b32 s53, s2, 4
    s_and_b32 s53, s53, 15
    s_lshr_b32 s54, s53, 3
    s_lshl_b32 s59, s52, 1
    s_add_u32 s54, s54, s59
    s_and_b32 s55, s53, 7
    s_xor_b32 s55, s55, 0
    s_and_b32 s56, s64, 3
    s_add_u32 s69, s54, s55
    s_and_b32 s69, s69, 3
    s_mul_i32 s58, s53, 3
    s_sub_i32 s59, s53, 11
    s_max_i32 s59, s59, 0
    s_sub_u32 s58, s58, s59
    s_cmp_ge_u32 s64, 4
    s_cbranch_scc1 Lloader
    s_setprio 1
    s_mov_b32 s6, 0x200000
    s_mov_b32 s7, 0x20000
    s_mov_b32 s26, 0x200000
    s_mov_b32 s27, 0x20000
    s_mov_b32 s34, 0x100
    s_mov_b32 s35, 0x20000
    s_mov_b32 s30, 0xc00000
    s_mov_b32 s31, 0x20000
    s_lshr_b32 s59, s55, 2
    s_add_u32 s59, s59, 1
    s_sub_i32 s60, 0, s59
    s_bitcmp1_b32 s55, 1
    s_cselect_b32 s59, s59, s60
    s_lshl_b32 s60, s54, 6
    s_lshl_b32 s61, s56, 4
    s_add_u32 s60, s60, s61
    s_add_i32 s59, s59, s60
    v_and_b32 v2, 15, v1
    v_lshrrev_b32 v3, 4, v1
    v_lshrrev_b32 v40, 3, v1
    v_and_b32 v41, 7, v1
    v_and_b32 v42, 6, v40
    v_xor_b32 v41, v41, v42
    v_lshlrev_b32 v41, 4, v41
    v_add_u32 v40, s59, v40
    v_mov_b32 v42, 0x40000000
    v_lshl_add_u32 v43, v40, 10, v41
    v_cmp_gt_u32 vcc, 2048, v40
    v_add_u32 v40, 8, v40
    s_nop 0
    v_cndmask_b32 v14, v42, v43, vcc
    v_lshl_add_u32 v43, v40, 10, v41
    v_cmp_gt_u32 vcc, 2048, v40
    s_lshl_b32 s66, s56, 14
    s_add_u32 s66, s66, 65536
    v_cndmask_b32 v15, v42, v43, vcc
    v_lshrrev_b32 v40, 3, v2
    v_lshlrev_b32 v40, 10, v40
    v_and_b32 v41, 7, v2
    v_lshl_add_u32 v40, v41, 7, v40
    v_and_b32 v41, 6, v2
    v_xor_b32 v41, v41, v3
    v_lshl_add_u32 v40, v41, 4, v40
    v_add_u32 v62, s66, v40
    v_xor_b32 v63, 64, v62
    v_mov_b32 v24, 0x3f803f80
    s_lshl_b32 s60, s52, 4
    v_mov_b32 v31, s60
    s_mov_b32 s57, 0
    s_waitcnt lgkmcnt(0)
    s_mov_b32 s4, s36
    s_mov_b32 s5, s37
    s_mov_b32 s32, s48
    s_mov_b32 s33, s49
    s_or_b32 s59, s53, s56
    s_cmp_lg_u32 s59, 0
    s_cbranch_scc1 Lnotag1
    s_or_b32 s71, s71, 0x40000000
    v_mov_b32 v40, s70
    v_mov_b32 v41, s71
    s_mov_b64 exec, 1
    buffer_store_dwordx2 v[40:41], v31, s[32:35], 0 offen sc1
    s_mov_b64 exec, -1
Lnotag1:
    s_add_u32 m0, s66, 0
    s_lshl_b32 s78, s69, 1
    s_add_u32 s78, s78, 0
    s_and_b32 s78, s78, 7
    s_lshl_b32 s78, s78, 7
    buffer_load_dwordx4 v14, s[4:7], s78 offen lds
    s_add_u32 m0, s66, 1024
    s_nop 0
    buffer_load_dwordx4 v15, s[4:7], s78 offen lds
    s_add_u32 m0, s66, 2048
    s_lshl_b32 s78, s69, 1
    s_add_u32 s78, s78, 1
    s_and_b32 s78, s78, 7
    s_lshl_b32 s78, s78, 7
    buffer_load_dwordx4 v14, s[4:7], s78 offen lds
    s_add_u32 m0, s66, 3072
    s_nop 0
    buffer_load_dwordx4 v15, s[4:7], s78 offen lds
    s_add_u32 m0, s66, 4096
    s_lshl_b32 s78, s69, 1
    s_add_u32 s78, s78, 2
    s_and_b32 s78, s78, 7
    s_lshl_b32 s78, s78, 7
    buffer_load_dwordx4 v14, s[4:7], s78 offen lds
    s_add_u32 m0, s66, 5120
    s_nop 0
    buffer_load_dwordx4 v15, s[4:7], s78 offen lds
    s_add_u32 m0, s66, 6144
    s_lshl_b32 s78, s69, 1
    s_add_u32 s78, s78, 3
    s_and_b32 s78, s78, 7
    s_lshl_b32 s78, s78, 7
    buffer_load_dwordx4 v14, s[4:7], s78 offen lds
    s_add_u32 m0, s66, 7168
    s_nop 0
    buffer_load_dwordx4 v15, s[4:7], s78 offen lds
    s_mov_b32 s24, s46
    s_mov_b32 s25, s47
    s_mov_b32 s28, s50
    s_mov_b32 s29, s51
    s_mov_b32 s74, 0xc0135761
    s_mov_b32 s75, 0xc0135761
    s_mov_b32 s76, 0xbdd2d3e8
    s_mov_b32 s77, 0xbdd2d3e8
    s_mov_b32 s81, 0xffff0000
    s_nop 0
    v_mov_b32 v25, 0x3f803f80
    v_mov_b32 v26, 0x3f803f80
    v_mov_b32 v27, 0x3f803f80
    v_mov_b32 v36, s74
    v_mov_b32 v37, s74
    v_lshrrev_b32 v40, 4, v1
    v_bfe_u32 v41, v1, 2, 2
    v_mul_u32_u24 v42, 8, v40
    v_add_u32 v42, v42, v41
    v_lshlrev_b32 v42, 7, v42
    v_bfe_u32 v43, v1, 1, 1
    v_lshl_add_u32 v42, v43, 4, v42
    v_and_b32 v43, 1, v1
    v_lshl_add_u32 v42, v43, 3, v42
    v_lshrrev_b32 v41, 1, v41
    v_and_b32 v40, 1, v40
    v_lshlrev_b32 v40, 1, v40
    v_or_b32 v40, v40, v41
    v_lshlrev_b32 v40, 5, v40
    v_xor_b32 v41, 0, v40
    v_add_u32 v8, v41, v42
    v_xor_b32 v41, 32, v40
    v_add_u32 v9, v41, v42
    v_xor_b32 v41, 64, v40
    v_add_u32 v10, v41, v42
    v_xor_b32 v41, 96, v40
    v_add_u32 v11, v41, v42
    s_lshl_b32 s60, s56, 5
    v_xor_b32 v41, s60, v40
    v_add_u32 v12, v41, v42
    v_lshrrev_b32 v40, 4, v1
    v_bfe_u32 v41, v1, 2, 2
    v_mul_u32_u24 v42, 4, v40
    v_add_u32 v42, v42, v41
    v_lshlrev_b32 v42, 7, v42
    v_bfe_u32 v43, v1, 1, 1
    v_lshl_add_u32 v42, v43, 4, v42
    v_and_b32 v43, 1, v1
    v_lshl_add_u32 v42, v43, 3, v42
    v_lshrrev_b32 v41, 1, v41
    v_and_b32 v40, 1, v40
    v_lshlrev_b32 v40, 1, v40
    v_or_b32 v40, v40, v41
    v_lshlrev_b32 v40, 5, v40
    v_add_u32 v42, 65536, v42
    v_xor_b32 v41, 0, v40
    v_add_u32 v248, v41, v42
    v_xor_b32 v41, 32, v40
    v_add_u32 v249, v41, v42
    v_xor_b32 v41, 64, v40
    v_add_u32 v250, v41, v42
    v_xor_b32 v41, 96, v40
    v_add_u32 v251, v41, v42
    s_lshl_b32 s59, s54, 2
    s_add_u32 s59, s59, s56
    s_lshl_b32 s59, s59, 14
    s_add_u32 s59, s59, 1048576
    v_lshlrev_b32 v40, 4, v1
    v_add_u32 v244, s59, v40
    s_lshl_b32 s60, s55, 11
    v_add_u32 v156, s60, v244
    s_and_b32 s59, s54, 1
    s_lshl_b32 s59, s59, 5
    s_lshl_b32 s60, s56, 3
    s_add_u32 s59, s59, s60
    s_add_u32 s60, s59, s55
    s_lshl_b32 s60, s60, 3
    s_lshl_b32 s63, s52, 12
    s_add_u32 s60, s60, s63
    v_mov_b32 v30, s60
    s_lshl_b32 s59, s59, 3
    s_add_u32 s59, s59, s63
    v_and_b32 v40, 7, v1
    v_lshlrev_b32 v40, 3, v40
    v_add_u32 v252, s59, v40
    s_add_u32 s63, s63, 1536
    v_lshlrev_b32 v40, 3, v2
    v_add_u32 v157, s63, v40
    s_lshl_b32 s59, s54, 6
    s_lshl_b32 s60, s56, 4
    s_add_u32 s59, s59, s60
    v_add_u32 v40, s59, v2
    v_lshlrev_b32 v41, 10, v40
    v_lshl_add_u32 v41, v3, 3, v41
    s_lshl_b32 s60, s55, 7
    v_add_u32 v247, s60, v41
    s_lshl_b32 s60, s55, 11
    v_add_u32 v40, s60, v40
    v_lshlrev_b32 v40, 3, v40
    v_add_u32 v246, 65536, v40
    s_lshl_b32 s59, s54, 1
    s_lshr_b32 s60, s56, 1
    s_add_u32 s59, s59, s60
    s_lshl_b32 s59, s59, 15
    s_lshl_b32 s60, s55, 12
    s_add_u32 s59, s59, s60
    s_and_b32 s60, s56, 1
    s_lshl_b32 s60, s60, 8
    s_add_u32 s59, s59, s60
    v_lshrrev_b32_e64 v40, 5, v1
    v_lshlrev_b32 v40, 10, v40
    v_bfe_u32 v41, v1, 4, 1
    v_lshl_add_u32 v40, v41, 9, v40
    v_lshl_add_u32 v40, v2, 4, v40
    v_add_u32 v245, s59, v40
    s_mul_i32 s37, s56, 3072
    s_waitcnt vmcnt(4)
    ds_read_b128 v[64:67], v62 offset:0
    ds_read_b128 v[68:71], v63 offset:0
    ds_read_b128 v[72:75], v62 offset:2048
    ds_read_b128 v[76:79], v63 offset:2048
    s_add_u32 m0, s66, 8192
    s_lshl_b32 s78, s69, 1
    s_add_u32 s78, s78, 4
    s_and_b32 s78, s78, 7
    s_lshl_b32 s78, s78, 7
    buffer_load_dwordx4 v14, s[4:7], s78 offen lds
    s_add_u32 m0, s66, 9216
    s_nop 0
    buffer_load_dwordx4 v15, s[4:7], s78 offen lds
    s_add_u32 m0, s66, 10240
    s_lshl_b32 s78, s69, 1
    s_add_u32 s78, s78, 5
    s_and_b32 s78, s78, 7
    s_lshl_b32 s78, s78, 7
    buffer_load_dwordx4 v14, s[4:7], s78 offen lds
    s_add_u32 m0, s66, 11264
    s_nop 0
    buffer_load_dwordx4 v15, s[4:7], s78 offen lds
    buffer_load_dwordx2 v[56:57], v31, s[32:35], 0 offen
    s_waitcnt lgkmcnt(0)
    s_nop 0
    v_dot2_f32_bf16 v44, v64, v24, 0
    v_dot2_f32_bf16 v46, v64, v64, 0
    v_dot2_f32_bf16 v45, v65, v24, 0
    v_dot2_f32_bf16 v47, v65, v65, 0
    v_dot2_f32_bf16 v44, v66, v24, v44
    v_dot2_f32_bf16 v46, v66, v66, v46
    v_dot2_f32_bf16 v45, v67, v24, v45
    v_dot2_f32_bf16 v47, v67, v67, v47
    v_dot2_f32_bf16 v44, v68, v24, v44
    v_dot2_f32_bf16 v46, v68, v68, v46
    v_dot2_f32_bf16 v45, v69, v24, v45
    v_dot2_f32_bf16 v47, v69, v69, v47
    v_dot2_f32_bf16 v44, v70, v24, v44
    v_dot2_f32_bf16 v46, v70, v70, v46
    v_dot2_f32_bf16 v45, v71, v24, v45
    v_dot2_f32_bf16 v47, v71, v71, v47
    v_dot2_f32_bf16 v44, v72, v24, v44
    v_dot2_f32_bf16 v46, v72, v72, v46
    v_dot2_f32_bf16 v45, v73, v24, v45
    v_dot2_f32_bf16 v47, v73, v73, v47
    v_dot2_f32_bf16 v44, v74, v24, v44
    v_dot2_f32_bf16 v46, v74, v74, v46
    v_dot2_f32_bf16 v45, v75, v24, v45
    v_dot2_f32_bf16 v47, v75, v75, v47
    v_dot2_f32_bf16 v44, v76, v24, v44
    v_dot2_f32_bf16 v46, v76, v76, v46
    v_dot2_f32_bf16 v45, v77, v24, v45
    v_dot2_f32_bf16 v47, v77, v77, v47
    v_dot2_f32_bf16 v44, v78, v24, v44
    v_dot2_f32_bf16 v46, v78, v78, v46
    v_dot2_f32_bf16 v45, v79, v24, v45
    v_dot2_f32_bf16 v47, v79, v79, v47
    s_barrier
    ds_read_b64_tr_b16 v[160:161], v8 offset:0
    ds_read_b64_tr_b16 v[162:163], v8 offset:512
    ds_read_b64_tr_b16 v[164:165], v9 offset:0
    ds_read_b64_tr_b16 v[166:167], v9 offset:512
    ds_read_b64_tr_b16 v[168:169], v10 offset:0
    ds_read_b64_tr_b16 v[170:171], v10 offset:512
    ds_read_b64_tr_b16 v[172:173], v11 offset:0
    ds_read_b64_tr_b16 v[174:175], v11 offset:512
    ds_read_b64_tr_b16 v[176:177], v8 offset:4096
    ds_read_b64_tr_b16 v[178:179], v8 offset:4608
    ds_read_b64_tr_b16 v[180:181], v9 offset:4096
    ds_read_b64_tr_b16 v[182:183], v9 offset:4608
    ds_read_b64_tr_b16 v[184:185], v10 offset:4096
    ds_read_b64_tr_b16 v[186:187], v10 offset:4608
    ds_read_b64_tr_b16 v[188:189], v11 offset:4096
    ds_read_b64_tr_b16 v[190:191], v11 offset:4608
    s_add_u32 m0, s66, 12288
    s_lshl_b32 s78, s69, 1
    s_add_u32 s78, s78, 6
    s_and_b32 s78, s78, 7
    s_lshl_b32 s78, s78, 7
    buffer_load_dwordx4 v14, s[4:7], s78 offen lds
    s_add_u32 m0, s66, 13312
    s_nop 0
    buffer_load_dwordx4 v15, s[4:7], s78 offen lds
    s_add_u32 m0, s66, 14336
    s_lshl_b32 s78, s69, 1
    s_add_u32 s78, s78, 7
    s_and_b32 s78, s78, 7
    s_lshl_b32 s78, s78, 7
    buffer_load_dwordx4 v14, s[4:7], s78 offen lds
    s_add_u32 m0, s66, 15360
    s_nop 0
    buffer_load_dwordx4 v15, s[4:7], s78 offen lds
    s_waitcnt lgkmcnt(8)
    v_mfma_f32_16x16x32_bf16 v[128:131], v[160:163], v[64:67], 0
    ds_read_b64_tr_b16 v[192:193], v8 offset:8192
    ds_read_b64_tr_b16 v[194:195], v8 offset:8704
    v_mfma_f32_16x16x32_bf16 v[132:135], v[164:167], v[64:67], 0
    ds_read_b64_tr_b16 v[196:197], v9 offset:8192
    ds_read_b64_tr_b16 v[198:199], v9 offset:8704
    v_mfma_f32_16x16x32_bf16 v[136:139], v[168:171], v[64:67], 0
    ds_read_b64_tr_b16 v[200:201], v10 offset:8192
    ds_read_b64_tr_b16 v[202:203], v10 offset:8704
    v_mfma_f32_16x16x32_bf16 v[140:143], v[172:175], v[64:67], 0
    ds_read_b64_tr_b16 v[204:205], v11 offset:8192
    ds_read_b64_tr_b16 v[206:207], v11 offset:8704
    ds_read_b64_tr_b16 v[208:209], v12 offset:0
    ds_read_b64_tr_b16 v[210:211], v12 offset:512
    ds_read_b64_tr_b16 v[212:213], v12 offset:4096
    ds_read_b64_tr_b16 v[214:215], v12 offset:4608
    ds_read_b64_tr_b16 v[216:217], v12 offset:8192
    ds_read_b64_tr_b16 v[218:219], v12 offset:8704
    ds_read_b64_tr_b16 v[220:221], v12 offset:12288
    ds_read_b64_tr_b16 v[222:223], v12 offset:12800
    s_waitcnt lgkmcnt(15)
    v_mfma_f32_16x16x32_bf16 v[128:131], v[176:179], v[68:71], v[128:131]
    ds_read_b64_tr_b16 v[160:161], v8 offset:12288
    ds_read_b64_tr_b16 v[162:163], v8 offset:12800
    v_mfma_f32_16x16x32_bf16 v[132:135], v[180:183], v[68:71], v[132:135]
    ds_read_b64_tr_b16 v[164:165], v9 offset:12288
    ds_read_b64_tr_b16 v[166:167], v9 offset:12800
    v_mfma_f32_16x16x32_bf16 v[136:139], v[184:187], v[68:71], v[136:139]
    ds_read_b64_tr_b16 v[168:169], v10 offset:12288
    ds_read_b64_tr_b16 v[170:171], v10 offset:12800
    v_mfma_f32_16x16x32_bf16 v[140:143], v[188:191], v[68:71], v[140:143]
    ds_read_b64_tr_b16 v[172:173], v11 offset:12288
    ds_read_b64_tr_b16 v[174:175], v11 offset:12800
    s_waitcnt lgkmcnt(8)
    v_mfma_f32_16x16x32_bf16 v[144:147], v[208:211], v[24:27], 0
    v_mfma_f32_16x16x32_bf16 v[144:147], v[212:215], v[24:27], v[144:147]
    v_mfma_f32_16x16x32_bf16 v[144:147], v[216:219], v[24:27], v[144:147]
    v_mfma_f32_16x16x32_bf16 v[144:147], v[220:223], v[24:27], v[144:147]
    s_barrier
    s_waitcnt vmcnt(9)
    ds_read_b128 v[80:83], v62 offset:4096
    ds_read_b128 v[84:87], v63 offset:4096
    ds_read_b128 v[88:91], v62 offset:6144
    ds_read_b128 v[92:95], v63 offset:6144
    v_mfma_f32_16x16x32_bf16 v[128:131], v[192:195], v[72:75], v[128:131]
    ds_read_b64_tr_b16 v[176:177], v8 offset:16384
    ds_read_b64_tr_b16 v[178:179], v8 offset:16896
    v_mfma_f32_16x16x32_bf16 v[132:135], v[196:199], v[72:75], v[132:135]
    ds_read_b64_tr_b16 v[180:181], v9 offset:16384
    ds_read_b64_tr_b16 v[182:183], v9 offset:16896
    v_mfma_f32_16x16x32_bf16 v[136:139], v[200:203], v[72:75], v[136:139]
    ds_read_b64_tr_b16 v[184:185], v10 offset:16384
    ds_read_b64_tr_b16 v[186:187], v10 offset:16896
    v_mfma_f32_16x16x32_bf16 v[140:143], v[204:207], v[72:75], v[140:143]
    ds_read_b64_tr_b16 v[188:189], v11 offset:16384
    ds_read_b64_tr_b16 v[190:191], v11 offset:16896
    ds_read_b64_tr_b16 v[208:209], v12 offset:16384
    ds_read_b64_tr_b16 v[210:211], v12 offset:16896
    ds_read_b64_tr_b16 v[212:213], v12 offset:20480
    ds_read_b64_tr_b16 v[214:215], v12 offset:20992
    ds_read_b64_tr_b16 v[216:217], v12 offset:24576
    ds_read_b64_tr_b16 v[218:219], v12 offset:25088
    ds_read_b64_tr_b16 v[220:221], v12 offset:28672
    ds_read_b64_tr_b16 v[222:223], v12 offset:29184
    s_waitcnt lgkmcnt(15)
    v_mfma_f32_16x16x32_bf16 v[128:131], v[160:163], v[76:79], v[128:131]
    ds_read_b64_tr_b16 v[192:193], v8 offset:20480
    ds_read_b64_tr_b16 v[194:195], v8 offset:20992
    v_mfma_f32_16x16x32_bf16 v[132:135], v[164:167], v[76:79], v[132:135]
    ds_read_b64_tr_b16 v[196:197], v9 offset:20480
    ds_read_b64_tr_b16 v[198:199], v9 offset:20992
    v_mfma_f32_16x16x32_bf16 v[136:139], v[168:171], v[76:79], v[136:139]
    ds_read_b64_tr_b16 v[200:201], v10 offset:20480
    ds_read_b64_tr_b16 v[202:203], v10 offset:20992
    v_mfma_f32_16x16x32_bf16 v[140:143], v[172:175], v[76:79], v[140:143]
    ds_read_b64_tr_b16 v[204:205], v11 offset:20480
    ds_read_b64_tr_b16 v[206:207], v11 offset:20992
    s_waitcnt lgkmcnt(8)
    v_mfma_f32_16x16x32_bf16 v[144:147], v[208:211], v[24:27], v[144:147]
    v_mfma_f32_16x16x32_bf16 v[144:147], v[212:215], v[24:27], v[144:147]
    v_mfma_f32_16x16x32_bf16 v[144:147], v[216:219], v[24:27], v[144:147]
    v_mfma_f32_16x16x32_bf16 v[144:147], v[220:223], v[24:27], v[144:147]
    v_dot2_f32_bf16 v44, v80, v24, v44
    v_dot2_f32_bf16 v46, v80, v80, v46
    v_dot2_f32_bf16 v45, v81, v24, v45
    v_dot2_f32_bf16 v47, v81, v81, v47
    v_dot2_f32_bf16 v44, v82, v24, v44
    v_dot2_f32_bf16 v46, v82, v82, v46
    v_dot2_f32_bf16 v45, v83, v24, v45
    v_dot2_f32_bf16 v47, v83, v83, v47
    v_dot2_f32_bf16 v44, v84, v24, v44
    v_dot2_f32_bf16 v46, v84, v84, v46
    v_dot2_f32_bf16 v45, v85, v24, v45
    v_dot2_f32_bf16 v47, v85, v85, v47
    v_dot2_f32_bf16 v44, v86, v24, v44
    v_dot2_f32_bf16 v46, v86, v86, v46
    v_dot2_f32_bf16 v45, v87, v24, v45
    v_dot2_f32_bf16 v47, v87, v87, v47
    v_dot2_f32_bf16 v44, v88, v24, v44
    v_dot2_f32_bf16 v46, v88, v88, v46
    v_dot2_f32_bf16 v45, v89, v24, v45
    v_dot2_f32_bf16 v47, v89, v89, v47
    v_dot2_f32_bf16 v44, v90, v24, v44
    v_dot2_f32_bf16 v46, v90, v90, v46
    v_dot2_f32_bf16 v45, v91, v24, v45
    v_dot2_f32_bf16 v47, v91, v91, v47
    v_dot2_f32_bf16 v44, v92, v24, v44
    v_dot2_f32_bf16 v46, v92, v92, v46
    v_dot2_f32_bf16 v45, v93, v24, v45
    v_dot2_f32_bf16 v47, v93, v93, v47
    v_dot2_f32_bf16 v44, v94, v24, v44
    v_dot2_f32_bf16 v46, v94, v94, v46
    v_dot2_f32_bf16 v45, v95, v24, v45
    v_dot2_f32_bf16 v47, v95, v95, v47
    v_mfma_f32_16x16x32_bf16 v[128:131], v[176:179], v[80:83], v[128:131]
    ds_read_b64_tr_b16 v[160:161], v8 offset:24576
    ds_read_b64_tr_b16 v[162:163], v8 offset:25088
    v_mfma_f32_16x16x32_bf16 v[132:135], v[180:183], v[80:83], v[132:135]
    ds_read_b64_tr_b16 v[164:165], v9 offset:24576
    ds_read_b64_tr_b16 v[166:167], v9 offset:25088
    v_mfma_f32_16x16x32_bf16 v[136:139], v[184:187], v[80:83], v[136:139]
    ds_read_b64_tr_b16 v[168:169], v10 offset:24576
    ds_read_b64_tr_b16 v[170:171], v10 offset:25088
    v_mfma_f32_16x16x32_bf16 v[140:143], v[188:191], v[80:83], v[140:143]
    ds_read_b64_tr_b16 v[172:173], v11 offset:24576
    ds_read_b64_tr_b16 v[174:175], v11 offset:25088
    s_waitcnt lgkmcnt(8)
    v_mfma_f32_16x16x32_bf16 v[128:131], v[192:195], v[84:87], v[128:131]
    ds_read_b64_tr_b16 v[176:177], v8 offset:28672
    ds_read_b64_tr_b16 v[178:179], v8 offset:29184
    v_mfma_f32_16x16x32_bf16 v[132:135], v[196:199], v[84:87], v[132:135]
    ds_read_b64_tr_b16 v[180:181], v9 offset:28672
    ds_read_b64_tr_b16 v[182:183], v9 offset:29184
    v_mfma_f32_16x16x32_bf16 v[136:139], v[200:203], v[84:87], v[136:139]
    ds_read_b64_tr_b16 v[184:185], v10 offset:28672
    ds_read_b64_tr_b16 v[186:187], v10 offset:29184
    v_mfma_f32_16x16x32_bf16 v[140:143], v[204:207], v[84:87], v[140:143]
    ds_read_b64_tr_b16 v[188:189], v11 offset:28672
    ds_read_b64_tr_b16 v[190:191], v11 offset:29184
    s_barrier
    s_waitcnt vmcnt(5)
    ds_read_b128 v[96:99], v62 offset:8192
    ds_read_b128 v[100:103], v63 offset:8192
    ds_read_b128 v[104:107], v62 offset:10240
    ds_read_b128 v[108:111], v63 offset:10240
    s_waitcnt lgkmcnt(12)
    v_mfma_f32_16x16x32_bf16 v[128:131], v[160:163], v[88:91], v[128:131]
    ds_read_b64_tr_b16 v[192:193], v8 offset:32768
    ds_read_b64_tr_b16 v[194:195], v8 offset:33280
    v_mfma_f32_16x16x32_bf16 v[132:135], v[164:167], v[88:91], v[132:135]
    ds_read_b64_tr_b16 v[196:197], v9 offset:32768
    ds_read_b64_tr_b16 v[198:199], v9 offset:33280
    v_mfma_f32_16x16x32_bf16 v[136:139], v[168:171], v[88:91], v[136:139]
    ds_read_b64_tr_b16 v[200:201], v10 offset:32768
    ds_read_b64_tr_b16 v[202:203], v10 offset:33280
    v_mfma_f32_16x16x32_bf16 v[140:143], v[172:175], v[88:91], v[140:143]
    ds_read_b64_tr_b16 v[204:205], v11 offset:32768
    ds_read_b64_tr_b16 v[206:207], v11 offset:33280
    ds_read_b64_tr_b16 v[208:209], v12 offset:32768
    ds_read_b64_tr_b16 v[210:211], v12 offset:33280
    ds_read_b64_tr_b16 v[212:213], v12 offset:36864
    ds_read_b64_tr_b16 v[214:215], v12 offset:37376
    ds_read_b64_tr_b16 v[216:217], v12 offset:40960
    ds_read_b64_tr_b16 v[218:219], v12 offset:41472
    ds_read_b64_tr_b16 v[220:221], v12 offset:45056
    ds_read_b64_tr_b16 v[222:223], v12 offset:45568
    s_waitcnt lgkmcnt(15)
    v_mfma_f32_16x16x32_bf16 v[128:131], v[176:179], v[92:95], v[128:131]
    ds_read_b64_tr_b16 v[160:161], v8 offset:36864
    ds_read_b64_tr_b16 v[162:163], v8 offset:37376
    v_mfma_f32_16x16x32_bf16 v[132:135], v[180:183], v[92:95], v[132:135]
    ds_read_b64_tr_b16 v[164:165], v9 offset:36864
    ds_read_b64_tr_b16 v[166:167], v9 offset:37376
    v_mfma_f32_16x16x32_bf16 v[136:139], v[184:187], v[92:95], v[136:139]
    ds_read_b64_tr_b16 v[168:169], v10 offset:36864
    ds_read_b64_tr_b16 v[170:171], v10 offset:37376
    v_mfma_f32_16x16x32_bf16 v[140:143], v[188:191], v[92:95], v[140:143]
    ds_read_b64_tr_b16 v[172:173], v11 offset:36864
    ds_read_b64_tr_b16 v[174:175], v11 offset:37376
    s_lshl_b32 s59, s56, 11
    s_add_u32 s59, s59, 155648
    v_lshlrev_b32 v40, 7, v2
    v_lshl_add_u32 v40, v3, 3, v40
    v_add_u32 v40, s59, v40
    ds_read_b64 v[16:17], v40 offset:0
    ds_read_b64 v[18:19], v40 offset:32
    ds_read_b64 v[20:21], v40 offset:64
    ds_read_b64 v[22:23], v40 offset:96
    s_waitcnt lgkmcnt(12)
    v_mfma_f32_16x16x32_bf16 v[144:147], v[208:211], v[24:27], v[144:147]
    v_mfma_f32_16x16x32_bf16 v[144:147], v[212:215], v[24:27], v[144:147]
    v_mfma_f32_16x16x32_bf16 v[144:147], v[216:219], v[24:27], v[144:147]
    v_mfma_f32_16x16x32_bf16 v[144:147], v[220:223], v[24:27], v[144:147]
    s_nop 0
    v_dot2_f32_bf16 v44, v96, v24, v44
    v_dot2_f32_bf16 v46, v96, v96, v46
    v_dot2_f32_bf16 v45, v97, v24, v45
    v_dot2_f32_bf16 v47, v97, v97, v47
    v_dot2_f32_bf16 v44, v98, v24, v44
    v_dot2_f32_bf16 v46, v98, v98, v46
    v_dot2_f32_bf16 v45, v99, v24, v45
    v_dot2_f32_bf16 v47, v99, v99, v47
    v_dot2_f32_bf16 v44, v100, v24, v44
    v_dot2_f32_bf16 v46, v100, v100, v46
    v_dot2_f32_bf16 v45, v101, v24, v45
    v_dot2_f32_bf16 v47, v101, v101, v47
    v_dot2_f32_bf16 v44, v102, v24, v44
    v_dot2_f32_bf16 v46, v102, v102, v46
    v_dot2_f32_bf16 v45, v103, v24, v45
    v_dot2_f32_bf16 v47, v103, v103, v47
    v_dot2_f32_bf16 v44, v104, v24, v44
    v_dot2_f32_bf16 v46, v104, v104, v46
    v_dot2_f32_bf16 v45, v105, v24, v45
    v_dot2_f32_bf16 v47, v105, v105, v47
    v_dot2_f32_bf16 v44, v106, v24, v44
    v_dot2_f32_bf16 v46, v106, v106, v46
    v_dot2_f32_bf16 v45, v107, v24, v45
    v_dot2_f32_bf16 v47, v107, v107, v47
    v_dot2_f32_bf16 v44, v108, v24, v44
    v_dot2_f32_bf16 v46, v108, v108, v46
    v_dot2_f32_bf16 v45, v109, v24, v45
    v_dot2_f32_bf16 v47, v109, v109, v47
    v_dot2_f32_bf16 v44, v110, v24, v44
    v_dot2_f32_bf16 v46, v110, v110, v46
    v_dot2_f32_bf16 v45, v111, v24, v45
    v_dot2_f32_bf16 v47, v111, v111, v47
    v_mfma_f32_16x16x32_bf16 v[128:131], v[192:195], v[96:99], v[128:131]
    ds_read_b64_tr_b16 v[176:177], v8 offset:40960
    ds_read_b64_tr_b16 v[178:179], v8 offset:41472
    v_mfma_f32_16x16x32_bf16 v[132:135], v[196:199], v[96:99], v[132:135]
    ds_read_b64_tr_b16 v[180:181], v9 offset:40960
    ds_read_b64_tr_b16 v[182:183], v9 offset:41472
    v_mfma_f32_16x16x32_bf16 v[136:139], v[200:203], v[96:99], v[136:139]
    ds_read_b64_tr_b16 v[184:185], v10 offset:40960
    ds_read_b64_tr_b16 v[186:187], v10 offset:41472
    v_mfma_f32_16x16x32_bf16 v[140:143], v[204:207], v[96:99], v[140:143]
    ds_read_b64_tr_b16 v[188:189], v11 offset:40960
    ds_read_b64_tr_b16 v[190:191], v11 offset:41472
    s_waitcnt lgkmcnt(12)
    v_mfma_f32_16x16x32_bf16 v[128:131], v[160:163], v[100:103], v[128:131]
    ds_read_b64_tr_b16 v[192:193], v8 offset:45056
    ds_read_b64_tr_b16 v[194:195], v8 offset:45568
    v_mfma_f32_16x16x32_bf16 v[132:135], v[164:167], v[100:103], v[132:135]
    ds_read_b64_tr_b16 v[196:197], v9 offset:45056
    ds_read_b64_tr_b16 v[198:199], v9 offset:45568
    v_mfma_f32_16x16x32_bf16 v[136:139], v[168:171], v[100:103], v[136:139]
    ds_read_b64_tr_b16 v[200:201], v10 offset:45056
    ds_read_b64_tr_b16 v[202:203], v10 offset:45568
    v_mfma_f32_16x16x32_bf16 v[140:143], v[172:175], v[100:103], v[140:143]
    ds_read_b64_tr_b16 v[204:205], v11 offset:45056
    ds_read_b64_tr_b16 v[206:207], v11 offset:45568
    s_barrier
    s_waitcnt vmcnt(0)
    ds_read_b128 v[112:115], v62 offset:12288
    ds_read_b128 v[116:119], v63 offset:12288
    ds_read_b128 v[120:123], v62 offset:14336
    ds_read_b128 v[124:127], v63 offset:14336
    s_waitcnt lgkmcnt(12)
    v_mfma_f32_16x16x32_bf16 v[128:131], v[176:179], v[104:107], v[128:131]
    ds_read_b64_tr_b16 v[160:161], v8 offset:49152
    ds_read_b64_tr_b16 v[162:163], v8 offset:49664
    v_mfma_f32_16x16x32_bf16 v[132:135], v[180:183], v[104:107], v[132:135]
    ds_read_b64_tr_b16 v[164:165], v9 offset:49152
    ds_read_b64_tr_b16 v[166:167], v9 offset:49664
    v_mfma_f32_16x16x32_bf16 v[136:139], v[184:187], v[104:107], v[136:139]
    ds_read_b64_tr_b16 v[168:169], v10 offset:49152
    ds_read_b64_tr_b16 v[170:171], v10 offset:49664
    v_mfma_f32_16x16x32_bf16 v[140:143], v[188:191], v[104:107], v[140:143]
    ds_read_b64_tr_b16 v[172:173], v11 offset:49152
    ds_read_b64_tr_b16 v[174:175], v11 offset:49664
    ds_read_b64_tr_b16 v[208:209], v12 offset:49152
    ds_read_b64_tr_b16 v[210:211], v12 offset:49664
    ds_read_b64_tr_b16 v[212:213], v12 offset:53248
    ds_read_b64_tr_b16 v[214:215], v12 offset:53760
    ds_read_b64_tr_b16 v[216:217], v12 offset:57344
    ds_read_b64_tr_b16 v[218:219], v12 offset:57856
    ds_read_b64_tr_b16 v[220:221], v12 offset:61440
    ds_read_b64_tr_b16 v[222:223], v12 offset:61952
    s_mov_b32 s80, 0
Ltag2:
    v_readfirstlane_b32 s50, v56
    v_readfirstlane_b32 s51, v57
    s_nop 3
    s_cmp_lg_u32 s51, 0
    s_cbranch_scc1 Ltagok3
    s_add_u32 s80, s80, 1
    s_cmp_gt_u32 s80, 0x40000
    s_cbranch_scc1 Ltagok3
    s_sleep 4
    buffer_load_dwordx2 v[56:57], v31, s[32:35], 0 offen sc1
    s_waitcnt vmcnt(0)
    s_branch Ltag2
Ltagok3:
    s_cmp_lg_u32 s56, 0
    s_cbranch_scc1 Ltagskip4
    s_getreg_b32 s59, hwreg(HW_REG_XCC_ID, 0, 4)
    s_xor_b32 s59, s59, s50
    v_mov_b32 v56, s59
    v_mov_b32 v57, s51
    s_lshl_b32 s59, s53, 3
    s_lshl_b32 s60, s52, 12
    s_add_u32 s59, s59, s60
    s_add_u32 s59, s59, 1536
    v_mov_b32 v58, s59
    s_mov_b64 exec, 1
    buffer_store_dwordx2 v[56:57], v58, s[28:31], 0 offen sc1
    s_mov_b64 exec, -1
Ltagskip4:
    s_waitcnt lgkmcnt(15)
    v_mfma_f32_16x16x32_bf16 v[128:131], v[192:195], v[108:111], v[128:131]
    ds_read_b64_tr_b16 v[176:177], v8 offset:53248
    ds_read_b64_tr_b16 v[178:179], v8 offset:53760
    v_mfma_f32_16x16x32_bf16 v[132:135], v[196:199], v[108:111], v[132:135]
    ds_read_b64_tr_b16 v[180:181], v9 offset:53248
    ds_read_b64_tr_b16 v[182:183], v9 offset:53760
    v_mfma_f32_16x16x32_bf16 v[136:139], v[200:203], v[108:111], v[136:139]
    ds_read_b64_tr_b16 v[184:185], v10 offset:53248
    ds_read_b64_tr_b16 v[186:187], v10 offset:53760
    v_mfma_f32_16x16x32_bf16 v[140:143], v[204:207], v[108:111], v[140:143]
    ds_read_b64_tr_b16 v[188:189], v11 offset:53248
    ds_read_b64_tr_b16 v[190:191], v11 offset:53760
    s_waitcnt lgkmcnt(8)
    v_mfma_f32_16x16x32_bf16 v[144:147], v[208:211], v[24:27], v[144:147]
    v_mfma_f32_16x16x32_bf16 v[144:147], v[212:215], v[24:27], v[144:147]
    v_mfma_f32_16x16x32_bf16 v[144:147], v[216:219], v[24:27], v[144:147]
    v_mfma_f32_16x16x32_bf16 v[144:147], v[220:223], v[24:27], v[144:147]
    s_nop 0
    v_dot2_f32_bf16 v44, v112, v24, v44
    v_dot2_f32_bf16 v46, v112, v112, v46
    v_dot2_f32_bf16 v45, v113, v24, v45
    v_dot2_f32_bf16 v47, v113, v113, v47
    v_dot2_f32_bf16 v44, v114, v24, v44
    v_dot2_f32_bf16 v46, v114, v114, v46
    v_dot2_f32_bf16 v45, v115, v24, v45
    v_dot2_f32_bf16 v47, v115, v115, v47
    v_dot2_f32_bf16 v44, v116, v24, v44
    v_dot2_f32_bf16 v46, v116, v116, v46
    v_dot2_f32_bf16 v45, v117, v24, v45
    v_dot2_f32_bf16 v47, v117, v117, v47
    v_dot2_f32_bf16 v44, v118, v24, v44
    v_dot2_f32_bf16 v46, v118, v118, v46
    v_dot2_f32_bf16 v45, v119, v24, v45
    v_dot2_f32_bf16 v47, v119, v119, v47
    v_dot2_f32_bf16 v44, v120, v24, v44
    v_dot2_f32_bf16 v46, v120, v120, v46
    v_dot2_f32_bf16 v45, v121, v24, v45
    v_dot2_f32_bf16 v47, v121, v121, v47
    v_dot2_f32_bf16 v44, v122, v24, v44
    v_dot2_f32_bf16 v46, v122, v122, v46
    v_dot2_f32_bf16 v45, v123, v24, v45
    v_dot2_f32_bf16 v47, v123, v123, v47
    v_dot2_f32_bf16 v44, v124, v24, v44
    v_dot2_f32_bf16 v46, v124, v124, v46
    v_dot2_f32_bf16 v45, v125, v24, v45
    v_dot2_f32_bf16 v47, v125, v125, v47
    v_dot2_f32_bf16 v44, v126, v24, v44
    v_dot2_f32_bf16 v46, v126, v126, v46
    v_dot2_f32_bf16 v45, v127, v24, v45
    v_dot2_f32_bf16 v47, v127, v127, v47
    v_mfma_f32_16x16x32_bf16 v[128:131], v[160:163], v[112:115], v[128:131]
    ds_read_b64_tr_b16 v[192:193], v8 offset:57344
    ds_read_b64_tr_b16 v[194:195], v8 offset:57856
    v_add_f32 v44, v44, v45
    v_add_f32 v46, v46, v47
    v_mfma_f32_16x16x32_bf16 v[132:135], v[164:167], v[112:115], v[132:135]
    ds_read_b64_tr_b16 v[196:197], v9 offset:57344
    ds_read_b64_tr_b16 v[198:199], v9 offset:57856
    v_mov_b32 v45, v44
    v_mov_b32 v47, v46
    v_mfma_f32_16x16x32_bf16 v[136:139], v[168:171], v[112:115], v[136:139]
    ds_read_b64_tr_b16 v[200:201], v10 offset:57344
    ds_read_b64_tr_b16 v[202:203], v10 offset:57856
    v_permlane16_swap_b32 v44, v45
    v_permlane16_swap_b32 v46, v47
    v_mfma_f32_16x16x32_bf16 v[140:143], v[172:175], v[112:115], v[140:143]
    ds_read_b64_tr_b16 v[204:205], v11 offset:57344
    ds_read_b64_tr_b16 v[206:207], v11 offset:57856
    v_add_f32 v44, v44, v45
    v_add_f32 v46, v46, v47
    v_lshrrev_b32 v40, 4, v1
    v_lshlrev_b32 v40, 4, v40
    s_lshl_b32 s59, s56, 11
    s_add_u32 s59, s59, 155648
    v_add_u32 v41, s59, v40
    v_add_u32 v62, 155648, v40
    s_mov_b32 exec_lo, 0x00010001
    s_mov_b32 exec_hi, 0x00010001
    ds_write_b128 v41, v[144:147]
    s_mov_b64 exec, -1
    s_waitcnt lgkmcnt(0)
    s_barrier
    v_mfma_f32_16x16x32_bf16 v[128:131], v[176:179], v[116:119], v[128:131]
    ds_read_b64_tr_b16 v[160:161], v8 offset:61440
    ds_read_b64_tr_b16 v[162:163], v8 offset:61952
    v_mov_b32 v45, v44
    v_mov_b32 v47, v46
    v_mfma_f32_16x16x32_bf16 v[132:135], v[180:183], v[116:119], v[132:135]
    ds_read_b64_tr_b16 v[164:165], v9 offset:61440
    ds_read_b64_tr_b16 v[166:167], v9 offset:61952
    v_permlane32_swap_b32 v44, v45
    v_permlane32_swap_b32 v46, v47
    v_mfma_f32_16x16x32_bf16 v[136:139], v[184:187], v[116:119], v[136:139]
    ds_read_b64_tr_b16 v[168:169], v10 offset:61440
    ds_read_b64_tr_b16 v[170:171], v10 offset:61952
    v_add_f32 v44, v44, v45
    v_add_f32 v46, v46, v47
    v_mfma_f32_16x16x32_bf16 v[140:143], v[188:191], v[116:119], v[140:143]
    ds_read_b64_tr_b16 v[172:173], v11 offset:61440
    ds_read_b64_tr_b16 v[174:175], v11 offset:61952
    v_mul_f32 v32, 0xbb000000, v44
    v_mul_f32 v46, 0x3b000000, v46
    ds_read_b128 v[224:227], v62 offset:0
    ds_read_b128 v[228:231], v62 offset:2048
    ds_read_b128 v[232:235], v62 offset:4096
    ds_read_b128 v[236:239], v62 offset:6144
    v_mfma_f32_16x16x32_bf16 v[128:131], v[192:195], v[120:123], v[128:131]
    v_fma_f32 v46, -v32, v32, v46
    v_max_f32 v46, 0, v46
    v_mfma_f32_16x16x32_bf16 v[132:135], v[196:199], v[120:123], v[132:135]
    v_add_f32 v46, 0x3727c5ac, v46
    v_rsq_f32 v34, v46
    v_mfma_f32_16x16x32_bf16 v[136:139], v[200:203], v[120:123], v[136:139]
    v_mfma_f32_16x16x32_bf16 v[140:143], v[204:207], v[120:123], v[140:143]
    s_waitcnt lgkmcnt(4)
    v_mfma_f32_16x16x32_bf16 v[128:131], v[160:163], v[124:127], v[128:131]
    v_mfma_f32_16x16x32_bf16 v[132:135], v[164:167], v[124:127], v[132:135]
    v_mfma_f32_16x16x32_bf16 v[136:139], v[168:171], v[124:127], v[136:139]
    v_mfma_f32_16x16x32_bf16 v[140:143], v[172:175], v[124:127], v[140:143]
    s_waitcnt lgkmcnt(0)
    s_nop 3
    v_pk_fma_f32 v[128:129], v[224:225], v[32:33], v[128:129] op_sel_hi:[1,0,1]
    v_pk_fma_f32 v[130:131], v[226:227], v[32:33], v[130:131] op_sel_hi:[1,0,1]
    v_pk_fma_f32 v[132:133], v[228:229], v[32:33], v[132:133] op_sel_hi:[1,0,1]
    v_pk_fma_f32 v[134:135], v[230:231], v[32:33], v[134:135] op_sel_hi:[1,0,1]
    v_pk_fma_f32 v[136:137], v[232:233], v[32:33], v[136:137] op_sel_hi:[1,0,1]
    v_pk_fma_f32 v[138:139], v[234:235], v[32:33], v[138:139] op_sel_hi:[1,0,1]
    v_pk_fma_f32 v[140:141], v[236:237], v[32:33], v[140:141] op_sel_hi:[1,0,1]
    v_pk_fma_f32 v[142:143], v[238:239], v[32:33], v[142:143] op_sel_hi:[1,0,1]
    v_pk_mul_f32 v[128:129], v[128:129], v[34:35] op_sel_hi:[1,0]
    v_pk_mul_f32 v[130:131], v[130:131], v[34:35] op_sel_hi:[1,0]
    v_pk_mul_f32 v[132:133], v[132:133], v[34:35] op_sel_hi:[1,0]
    v_pk_mul_f32 v[134:135], v[134:135], v[34:35] op_sel_hi:[1,0]
    v_pk_mul_f32 v[40:41], v[128:129], v[128:129]
    v_pk_mul_f32 v[42:43], v[130:131], v[130:131]
    v_pk_mul_f32 v[44:45], v[132:133], v[132:133]
    v_pk_mul_f32 v[46:47], v[134:135], v[134:135]
    v_pk_fma_f32 v[40:41], v[40:41], s[76:77], v[36:37]
    v_pk_fma_f32 v[42:43], v[42:43], s[76:77], v[36:37]
    v_pk_fma_f32 v[44:45], v[44:45], s[76:77], v[36:37]
    v_pk_fma_f32 v[46:47], v[46:47], s[76:77], v[36:37]
    v_pk_mul_f32 v[40:41], v[40:41], v[128:129]
    v_pk_mul_f32 v[42:43], v[42:43], v[130:131]
    v_pk_mul_f32 v[44:45], v[44:45], v[132:133]
    v_pk_mul_f32 v[46:47], v[46:47], v[134:135]
    v_exp_f32 v40, v40
    v_exp_f32 v41, v41
    v_exp_f32 v42, v42
    v_exp_f32 v43, v43
    v_exp_f32 v44, v44
    v_exp_f32 v45, v45
    v_exp_f32 v46, v46
    v_exp_f32 v47, v47
    v_pk_add_f32 v[40:41], v[40:41], 1.0 op_sel_hi:[1,0]
    v_pk_add_f32 v[42:43], v[42:43], 1.0 op_sel_hi:[1,0]
    v_pk_add_f32 v[44:45], v[44:45], 1.0 op_sel_hi:[1,0]
    v_pk_add_f32 v[46:47], v[46:47], 1.0 op_sel_hi:[1,0]
    v_rcp_f32 v40, v40
    v_rcp_f32 v41, v41
    v_rcp_f32 v42, v42
    v_rcp_f32 v43, v43
    v_rcp_f32 v44, v44
    v_rcp_f32 v45, v45
    v_rcp_f32 v46, v46
    v_rcp_f32 v47, v47
    v_pk_mul_f32 v[128:129], v[128:129], v[40:41]
    v_pk_mul_f32 v[130:131], v[130:131], v[42:43]
    v_pk_mul_f32 v[132:133], v[132:133], v[44:45]
    v_pk_mul_f32 v[134:135], v[134:135], v[46:47]
    v_cvt_pk_bf16_f32 v56, v128, v129
    v_cvt_pk_bf16_f32 v57, v130, v131
    v_cvt_pk_bf16_f32 v58, v132, v133
    v_cvt_pk_bf16_f32 v59, v134, v135
    buffer_store_dwordx4 v[56:59], v156, s[28:31], 0 offen offset:0 sc1
    v_pk_mul_f32 v[136:137], v[136:137], v[34:35] op_sel_hi:[1,0]
    v_pk_mul_f32 v[138:139], v[138:139], v[34:35] op_sel_hi:[1,0]
    v_pk_mul_f32 v[140:141], v[140:141], v[34:35] op_sel_hi:[1,0]
    v_pk_mul_f32 v[142:143], v[142:143], v[34:35] op_sel_hi:[1,0]
    v_pk_mul_f32 v[40:41], v[136:137], v[136:137]
    v_pk_mul_f32 v[42:43], v[138:139], v[138:139]
    v_pk_mul_f32 v[44:45], v[140:141], v[140:141]
    v_pk_mul_f32 v[46:47], v[142:143], v[142:143]
    v_pk_fma_f32 v[40:41], v[40:41], s[76:77], v[36:37]
    v_pk_fma_f32 v[42:43], v[42:43], s[76:77], v[36:37]
    v_pk_fma_f32 v[44:45], v[44:45], s[76:77], v[36:37]
    v_pk_fma_f32 v[46:47], v[46:47], s[76:77], v[36:37]
    v_pk_mul_f32 v[40:41], v[40:41], v[136:137]
    v_pk_mul_f32 v[42:43], v[42:43], v[138:139]
    v_pk_mul_f32 v[44:45], v[44:45], v[140:141]
    v_pk_mul_f32 v[46:47], v[46:47], v[142:143]
    v_exp_f32 v40, v40
    v_exp_f32 v41, v41
    v_exp_f32 v42, v42
    v_exp_f32 v43, v43
    v_exp_f32 v44, v44
    v_exp_f32 v45, v45
    v_exp_f32 v46, v46
    v_exp_f32 v47, v47
    v_pk_add_f32 v[40:41], v[40:41], 1.0 op_sel_hi:[1,0]
    v_pk_add_f32 v[42:43], v[42:43], 1.0 op_sel_hi:[1,0]
    v_pk_add_f32 v[44:45], v[44:45], 1.0 op_sel_hi:[1,0]
    v_pk_add_f32 v[46:47], v[46:47], 1.0 op_sel_hi:[1,0]
    v_rcp_f32 v40, v40
    v_rcp_f32 v41, v41
    v_rcp_f32 v42, v42
    v_rcp_f32 v43, v43
    v_rcp_f32 v44, v44
    v_rcp_f32 v45, v45
    v_rcp_f32 v46, v46
    v_rcp_f32 v47, v47
    v_pk_mul_f32 v[136:137], v[136:137], v[40:41]
    v_pk_mul_f32 v[138:139], v[138:139], v[42:43]
    v_pk_mul_f32 v[140:141], v[140:141], v[44:45]
    v_pk_mul_f32 v[142:143], v[142:143], v[46:47]
    v_cvt_pk_bf16_f32 v60, v136, v137
    v_cvt_pk_bf16_f32 v61, v138, v139
    v_cvt_pk_bf16_f32 v62, v140, v141
    v_cvt_pk_bf16_f32 v63, v142, v143
    buffer_store_dwordx4 v[60:63], v156, s[28:31], 0 offen offset:1024 sc1
    buffer_load_dwordx2 v[158:159], v157, s[28:31], 0 offen sc1
    s_add_u32 s59, s69, 0
    s_and_b32 s59, s59, 3
    s_lshl_b32 s44, s59, 10
    s_add_u32 s59, s69, 1
    s_and_b32 s59, s59, 3
    s_lshl_b32 s45, s59, 10
    s_add_u32 s59, s69, 2
    s_and_b32 s59, s59, 3
    s_lshl_b32 s46, s59, 10
    s_add_u32 s59, s69, 3
    s_and_b32 s59, s59, 3
    s_lshl_b32 s47, s59, 10
    v_lshlrev_b32 v224, 16, v16
    v_and_b32 v225, s81, v16
    v_lshlrev_b32 v226, 16, v17
    v_and_b32 v227, s81, v17
    v_lshlrev_b32 v228, 16, v18
    v_and_b32 v229, s81, v18
    v_lshlrev_b32 v230, 16, v19
    v_and_b32 v231, s81, v19
    v_lshlrev_b32 v232, 16, v20
    v_and_b32 v233, s81, v20
    v_lshlrev_b32 v234, 16, v21
    v_and_b32 v235, s81, v21
    v_lshlrev_b32 v236, 16, v22
    v_and_b32 v237, s81, v22
    v_lshlrev_b32 v238, 16, v23
    v_and_b32 v239, s81, v23
    v_lshrrev_b32 v40, 5, v1
    v_bfe_u32 v41, v1, 2, 2
    v_lshl_add_u32 v42, v40, 2, v41
    v_lshlrev_b32 v42, 6, v42
    v_bfe_u32 v43, v1, 4, 1
    v_lshl_add_u32 v42, v43, 5, v42
    v_and_b32_e64 v43, 1, v1
    v_lshl_add_u32 v42, v43, 4, v42
    v_bfe_u32 v43, v1, 1, 1
    v_lshl_add_u32 v8, v43, 3, v42
    v_add_u32 v9, 131072, v8
    s_lshl_b32 s41, s52, 2
    s_add_u32 s41, s41, s56
    s_lshl_b32 s59, s41, 15
    v_lshlrev_b32 v40, 4, v1
    v_add_u32 v14, s59, v40
    s_mul_i32 s59, s41, 88064
    s_lshl_b32 s60, s58, 11
    s_add_u32 s59, s59, s60
    s_add_u32 s59, s59, 5242880
    v_add_u32 v15, s59, v40
    s_mov_b32 s42, 4096
    s_lshr_b32 s59, s56, 1
    s_lshl_b32 s59, s59, 5
    s_and_b32 s60, s56, 1
    s_lshl_b32 s60, s60, 4
    s_add_u32 s59, s59, s60
    s_lshl_b32 s59, s59, 3
    s_lshl_b32 s60, s52, 12
    s_add_u32 s59, s59, s60
    s_add_u32 s59, s59, 512
    v_and_b32 v40, 15, v1
    v_lshlrev_b32 v40, 3, v40
    v_add_u32 v4, s59, v40
    s_lshl_b32 s59, s56, 4
    s_add_u32 s59, s59, s53
    s_lshl_b32 s59, s59, 3
    s_add_u32 s59, s59, s60
    s_add_u32 s59, s59, 1024
    v_mov_b32 v5, s59
    s_lshr_b32 s38, s56, 1
    s_and_b32 s39, s56, 1
    s_lshl_b32 s59, s41, 8
    s_add_u32 s59, s59, 65536
    v_and_b32 v40, 31, v1
    v_lshlrev_b32 v40, 3, v40
    v_lshrrev_b32 v41, 5, v1
    v_lshl_add_u32 v40, v41, 16, v40
    v_add_u32 v6, s59, v40
    s_waitcnt vmcnt(1)
    s_waitcnt vmcnt(0)
    s_mov_b32 s80, 0
Lgrp5:
    v_xor_b32 v155, s50, v158
    v_cmp_ne_u32 vcc, s51, v159
    s_nop 3
    s_mov_b64 s[18:19], vcc
    v_cmp_le_u32 vcc, 16, v155
    s_nop 3
    s_or_b64 vcc, vcc, s[18:19]
    s_cbranch_vccz Lgrpok6
    s_add_u32 s80, s80, 1
    s_cmp_gt_u32 s80, 0x40000
    s_cbranch_scc1 Lgrpok6
    s_sleep 2
    buffer_load_dwordx2 v[158:159], v157, s[28:31], 0 offen sc1
    s_waitcnt vmcnt(0)
    s_branch Lgrp5
Lgrpok6:
    v_readfirstlane_b32 s20, v155
    s_nop 3
    v_cmp_ne_u32 vcc, s20, v155
    s_nop 3
    s_cmp_eq_u64 vcc, 0
    s_cselect_b32 s57, 1, 0
    v_mov_b32 v28, s50
    v_mov_b32 v29, s51
    s_mov_b64 exec, 1
    s_cmp_eq_u32 s57, 0
    s_cbranch_scc1 Lslow7
    buffer_store_dwordx2 v[28:29], v30, s[28:31], 0 offen
    s_branch Ldone8
Lslow7:
    buffer_store_dwordx2 v[28:29], v30, s[28:31], 0 offen sc1
Ldone8:
    s_mov_b64 exec, -1
    buffer_load_dwordx2 v[28:29], v252, s[28:31], 0 offen sc1
    s_mov_b32 s80, 0
Lpoll9:
    s_waitcnt vmcnt(0)
    v_cmp_ne_u64 vcc, s[50:51], v[28:29]
    s_cbranch_vccz Lpollok10
    s_add_u32 s80, s80, 1
    s_cmp_gt_u32 s80, 0x40000
    s_cbranch_scc1 Lpollok10
    s_cmp_lg_u32 s57, 0
    s_cbranch_scc1 Lnosleep11
    s_sleep 8
Lnosleep11:
    buffer_load_dwordx2 v[28:29], v252, s[28:31], 0 offen sc1
    s_branch Lpoll9
Lpollok10:
    s_add_u32 s78, s44, 0
    buffer_load_dwordx4 v[64:67], v244, s[28:31], s78 offen sc1
    s_add_u32 s78, s45, 0
    buffer_load_dwordx4 v[68:71], v244, s[28:31], s78 offen sc1
    s_add_u32 s78, s46, 0
    buffer_load_dwordx4 v[72:75], v244, s[28:31], s78 offen sc1
    s_barrier
    s_add_u32 s78, s47, 0
    buffer_load_dwordx4 v[76:79], v244, s[28:31], s78 offen sc1
    s_add_u32 s78, s44, 4096
    buffer_load_dwordx4 v[80:83], v244, s[28:31], s78 offen sc1
    s_add_u32 s78, s45, 4096
    buffer_load_dwordx4 v[84:87], v244, s[28:31], s78 offen sc1
    s_add_u32 s78, s46, 4096
    buffer_load_dwordx4 v[88:91], v244, s[28:31], s78 offen sc1
    s_add_u32 s78, s47, 4096
    buffer_load_dwordx4 v[92:95], v244, s[28:31], s78 offen sc1
    s_add_u32 s78, s44, 8192
    buffer_load_dwordx4 v[96:99], v244, s[28:31], s78 offen sc1
    s_add_u32 s78, s45, 8192
    buffer_load_dwordx4 v[100:103], v244, s[28:31], s78 offen sc1
    s_add_u32 s78, s46, 8192
    buffer_load_dwordx4 v[104:107], v244, s[28:31], s78 offen sc1
    s_add_u32 s78, s47, 8192
    buffer_load_dwordx4 v[108:111], v244, s[28:31], s78 offen sc1
    s_add_u32 s78, s44, 12288
    buffer_load_dwordx4 v[112:115], v244, s[28:31], s78 offen sc1
    s_add_u32 s78, s45, 12288
    buffer_load_dwordx4 v[116:119], v244, s[28:31], s78 offen sc1
    s_add_u32 s78, s46, 12288
    buffer_load_dwordx4 v[120:123], v244, s[28:31], s78 offen sc1
    s_add_u32 s78, s47, 12288
    buffer_load_dwordx4 v[124:127], v244, s[28:31], s78 offen sc1
    ds_read_b64_tr_b16 v[160:161], v248 offset:0
    ds_read_b64_tr_b16 v[162:163], v248 offset:2048
    ds_read_b64_tr_b16 v[164:165], v249 offset:0
    ds_read_b64_tr_b16 v[166:167], v249 offset:2048
    ds_read_b64_tr_b16 v[168:169], v250 offset:0
    ds_read_b64_tr_b16 v[170:171], v250 offset:2048
    ds_read_b64_tr_b16 v[172:173], v251 offset:0
    ds_read_b64_tr_b16 v[174:175], v251 offset:2048
    ds_read_b64_tr_b16 v[176:177], v248 offset:4096
    ds_read_b64_tr_b16 v[178:179], v248 offset:6144
    ds_read_b64_tr_b16 v[180:181], v249 offset:4096
    ds_read_b64_tr_b16 v[182:183], v249 offset:6144
    ds_read_b64_tr_b16 v[184:185], v250 offset:4096
    ds_read_b64_tr_b16 v[186:187], v250 offset:6144
    ds_read_b64_tr_b16 v[188:189], v251 offset:4096
    ds_read_b64_tr_b16 v[190:191], v251 offset:6144
    s_barrier
    s_waitcnt vmcnt(15) lgkmcnt(8)
    v_mfma_f32_16x16x32_bf16 v[128:131], v[160:163], v[64:67], 0
    ds_read_b64_tr_b16 v[192:193], v248 offset:8192
    ds_read_b64_tr_b16 v[194:195], v248 offset:10240
    v_mfma_f32_16x16x32_bf16 v[132:135], v[164:167], v[64:67], 0
    ds_read_b64_tr_b16 v[196:197], v249 offset:8192
    ds_read_b64_tr_b16 v[198:199], v249 offset:10240
    v_mfma_f32_16x16x32_bf16 v[136:139], v[168:171], v[64:67], 0
    ds_read_b64_tr_b16 v[200:201], v250 offset:8192
    ds_read_b64_tr_b16 v[202:203], v250 offset:10240
    v_mfma_f32_16x16x32_bf16 v[140:143], v[172:175], v[64:67], 0
    ds_read_b64_tr_b16 v[204:205], v251 offset:8192
    ds_read_b64_tr_b16 v[206:207], v251 offset:10240
    s_waitcnt vmcnt(14) lgkmcnt(8)
    v_mfma_f32_16x16x32_bf16 v[128:131], v[176:179], v[68:71], v[128:131]
    ds_read_b64_tr_b16 v[160:161], v248 offset:12288
    ds_read_b64_tr_b16 v[162:163], v248 offset:14336
    v_mfma_f32_16x16x32_bf16 v[132:135], v[180:183], v[68:71], v[132:135]
    ds_read_b64_tr_b16 v[164:165], v249 offset:12288
    ds_read_b64_tr_b16 v[166:167], v249 offset:14336
    v_mfma_f32_16x16x32_bf16 v[136:139], v[184:187], v[68:71], v[136:139]
    ds_read_b64_tr_b16 v[168:169], v250 offset:12288
    ds_read_b64_tr_b16 v[170:171], v250 offset:14336
    v_mfma_f32_16x16x32_bf16 v[140:143], v[188:191], v[68:71], v[140:143]
    ds_read_b64_tr_b16 v[172:173], v251 offset:12288
    ds_read_b64_tr_b16 v[174:175], v251 offset:14336
    s_waitcnt vmcnt(13) lgkmcnt(8)
    v_mfma_f32_16x16x32_bf16 v[128:131], v[192:195], v[72:75], v[128:131]
    ds_read_b64_tr_b16 v[176:177], v248 offset:16384
    ds_read_b64_tr_b16 v[178:179], v248 offset:18432
    v_mfma_f32_16x16x32_bf16 v[132:135], v[196:199], v[72:75], v[132:135]
    ds_read_b64_tr_b16 v[180:181], v249 offset:16384
    ds_read_b64_tr_b16 v[182:183], v249 offset:18432
    v_mfma_f32_16x16x32_bf16 v[136:139], v[200:203], v[72:75], v[136:139]
    ds_read_b64_tr_b16 v[184:185], v250 offset:16384
    ds_read_b64_tr_b16 v[186:187], v250 offset:18432
    v_mfma_f32_16x16x32_bf16 v[140:143], v[204:207], v[72:75], v[140:143]
    ds_read_b64_tr_b16 v[188:189], v251 offset:16384
    ds_read_b64_tr_b16 v[190:191], v251 offset:18432
    s_waitcnt vmcnt(12) lgkmcnt(8)
    v_mfma_f32_16x16x32_bf16 v[128:131], v[160:163], v[76:79], v[128:131]
    ds_read_b64_tr_b16 v[192:193], v248 offset:20480
    ds_read_b64_tr_b16 v[194:195], v248 offset:22528
    v_mfma_f32_16x16x32_bf16 v[132:135], v[164:167], v[76:79], v[132:135]
    ds_read_b64_tr_b16 v[196:197], v249 offset:20480
    ds_read_b64_tr_b16 v[198:199], v249 offset:22528
    v_mfma_f32_16x16x32_bf16 v[136:139], v[168:171], v[76:79], v[136:139]
    ds_read_b64_tr_b16 v[200:201], v250 offset:20480
    ds_read_b64_tr_b16 v[202:203], v250 offset:22528
    v_mfma_f32_16x16x32_bf16 v[140:143], v[172:175], v[76:79], v[140:143]
    ds_read_b64_tr_b16 v[204:205], v251 offset:20480
    ds_read_b64_tr_b16 v[206:207], v251 offset:22528
    s_waitcnt vmcnt(11) lgkmcnt(8)
    v_mfma_f32_16x16x32_bf16 v[128:131], v[176:179], v[80:83], v[128:131]
    ds_read_b64_tr_b16 v[160:161], v248 offset:24576
    ds_read_b64_tr_b16 v[162:163], v248 offset:26624
    v_mfma_f32_16x16x32_bf16 v[132:135], v[180:183], v[80:83], v[132:135]
    ds_read_b64_tr_b16 v[164:165], v249 offset:24576
    ds_read_b64_tr_b16 v[166:167], v249 offset:26624
    v_mfma_f32_16x16x32_bf16 v[136:139], v[184:187], v[80:83], v[136:139]
    ds_read_b64_tr_b16 v[168:169], v250 offset:24576
    ds_read_b64_tr_b16 v[170:171], v250 offset:26624
    v_mfma_f32_16x16x32_bf16 v[140:143], v[188:191], v[80:83], v[140:143]
    ds_read_b64_tr_b16 v[172:173], v251 offset:24576
    ds_read_b64_tr_b16 v[174:175], v251 offset:26624
    s_waitcnt vmcnt(10) lgkmcnt(8)
    v_mfma_f32_16x16x32_bf16 v[128:131], v[192:195], v[84:87], v[128:131]
    ds_read_b64_tr_b16 v[176:177], v248 offset:28672
    ds_read_b64_tr_b16 v[178:179], v248 offset:30720
    v_mfma_f32_16x16x32_bf16 v[132:135], v[196:199], v[84:87], v[132:135]
    ds_read_b64_tr_b16 v[180:181], v249 offset:28672
    ds_read_b64_tr_b16 v[182:183], v249 offset:30720
    v_mfma_f32_16x16x32_bf16 v[136:139], v[200:203], v[84:87], v[136:139]
    ds_read_b64_tr_b16 v[184:185], v250 offset:28672
    ds_read_b64_tr_b16 v[186:187], v250 offset:30720
    v_mfma_f32_16x16x32_bf16 v[140:143], v[204:207], v[84:87], v[140:143]
    ds_read_b64_tr_b16 v[188:189], v251 offset:28672
    ds_read_b64_tr_b16 v[190:191], v251 offset:30720
    s_waitcnt vmcnt(9) lgkmcnt(8)
    v_mfma_f32_16x16x32_bf16 v[128:131], v[160:163], v[88:91], v[128:131]
    ds_read_b64_tr_b16 v[192:193], v248 offset:32768
    ds_read_b64_tr_b16 v[194:195], v248 offset:34816
    v_mfma_f32_16x16x32_bf16 v[132:135], v[164:167], v[88:91], v[132:135]
    ds_read_b64_tr_b16 v[196:197], v249 offset:32768
    ds_read_b64_tr_b16 v[198:199], v249 offset:34816
    v_mfma_f32_16x16x32_bf16 v[136:139], v[168:171], v[88:91], v[136:139]
    ds_read_b64_tr_b16 v[200:201], v250 offset:32768
    ds_read_b64_tr_b16 v[202:203], v250 offset:34816
    v_mfma_f32_16x16x32_bf16 v[140:143], v[172:175], v[88:91], v[140:143]
    ds_read_b64_tr_b16 v[204:205], v251 offset:32768
    ds_read_b64_tr_b16 v[206:207], v251 offset:34816
    s_waitcnt vmcnt(8) lgkmcnt(8)
    v_mfma_f32_16x16x32_bf16 v[128:131], v[176:179], v[92:95], v[128:131]
    ds_read_b64_tr_b16 v[160:161], v248 offset:36864
    ds_read_b64_tr_b16 v[162:163], v248 offset:38912
    v_mfma_f32_16x16x32_bf16 v[132:135], v[180:183], v[92:95], v[132:135]
    ds_read_b64_tr_b16 v[164:165], v249 offset:36864
    ds_read_b64_tr_b16 v[166:167], v249 offset:38912
    v_mfma_f32_16x16x32_bf16 v[136:139], v[184:187], v[92:95], v[136:139]
    ds_read_b64_tr_b16 v[168:169], v250 offset:36864
    ds_read_b64_tr_b16 v[170:171], v250 offset:38912
    v_mfma_f32_16x16x32_bf16 v[140:143], v[188:191], v[92:95], v[140:143]
    ds_read_b64_tr_b16 v[172:173], v251 offset:36864
    ds_read_b64_tr_b16 v[174:175], v251 offset:38912
    s_waitcnt vmcnt(7) lgkmcnt(8)
    v_mfma_f32_16x16x32_bf16 v[128:131], v[192:195], v[96:99], v[128:131]
    ds_read_b64_tr_b16 v[176:177], v248 offset:40960
    ds_read_b64_tr_b16 v[178:179], v248 offset:43008
    v_mfma_f32_16x16x32_bf16 v[132:135], v[196:199], v[96:99], v[132:135]
    ds_read_b64_tr_b16 v[180:181], v249 offset:40960
    ds_read_b64_tr_b16 v[182:183], v249 offset:43008
    v_mfma_f32_16x16x32_bf16 v[136:139], v[200:203], v[96:99], v[136:139]
    ds_read_b64_tr_b16 v[184:185], v250 offset:40960
    ds_read_b64_tr_b16 v[186:187], v250 offset:43008
    v_mfma_f32_16x16x32_bf16 v[140:143], v[204:207], v[96:99], v[140:143]
    ds_read_b64_tr_b16 v[188:189], v251 offset:40960
    ds_read_b64_tr_b16 v[190:191], v251 offset:43008
    s_waitcnt vmcnt(6) lgkmcnt(8)
    v_mfma_f32_16x16x32_bf16 v[128:131], v[160:163], v[100:103], v[128:131]
    ds_read_b64_tr_b16 v[192:193], v248 offset:45056
    ds_read_b64_tr_b16 v[194:195], v248 offset:47104
    v_mfma_f32_16x16x32_bf16 v[132:135], v[164:167], v[100:103], v[132:135]
    ds_read_b64_tr_b16 v[196:197], v249 offset:45056
    ds_read_b64_tr_b16 v[198:199], v249 offset:47104
    v_mfma_f32_16x16x32_bf16 v[136:139], v[168:171], v[100:103], v[136:139]
    ds_read_b64_tr_b16 v[200:201], v250 offset:45056
    ds_read_b64_tr_b16 v[202:203], v250 offset:47104
    v_mfma_f32_16x16x32_bf16 v[140:143], v[172:175], v[100:103], v[140:143]
    ds_read_b64_tr_b16 v[204:205], v251 offset:45056
    ds_read_b64_tr_b16 v[206:207], v251 offset:47104
    s_waitcnt vmcnt(5) lgkmcnt(8)
    v_mfma_f32_16x16x32_bf16 v[128:131], v[176:179], v[104:107], v[128:131]
    ds_read_b64_tr_b16 v[160:161], v248 offset:49152
    ds_read_b64_tr_b16 v[162:163], v248 offset:51200
    v_mfma_f32_16x16x32_bf16 v[132:135], v[180:183], v[104:107], v[132:135]
    ds_read_b64_tr_b16 v[164:165], v249 offset:49152
    ds_read_b64_tr_b16 v[166:167], v249 offset:51200
    v_mfma_f32_16x16x32_bf16 v[136:139], v[184:187], v[104:107], v[136:139]
    ds_read_b64_tr_b16 v[168:169], v250 offset:49152
    ds_read_b64_tr_b16 v[170:171], v250 offset:51200
    v_mfma_f32_16x16x32_bf16 v[140:143], v[188:191], v[104:107], v[140:143]
    ds_read_b64_tr_b16 v[172:173], v251 offset:49152
    ds_read_b64_tr_b16 v[174:175], v251 offset:51200
    s_waitcnt vmcnt(4) lgkmcnt(8)
    v_mfma_f32_16x16x32_bf16 v[128:131], v[192:195], v[108:111], v[128:131]
    ds_read_b64_tr_b16 v[176:177], v248 offset:53248
    ds_read_b64_tr_b16 v[178:179], v248 offset:55296
    v_mfma_f32_16x16x32_bf16 v[132:135], v[196:199], v[108:111], v[132:135]
    ds_read_b64_tr_b16 v[180:181], v249 offset:53248
    ds_read_b64_tr_b16 v[182:183], v249 offset:55296
    v_mfma_f32_16x16x32_bf16 v[136:139], v[200:203], v[108:111], v[136:139]
    ds_read_b64_tr_b16 v[184:185], v250 offset:53248
    ds_read_b64_tr_b16 v[186:187], v250 offset:55296
    v_mfma_f32_16x16x32_bf16 v[140:143], v[204:207], v[108:111], v[140:143]
    ds_read_b64_tr_b16 v[188:189], v251 offset:53248
    ds_read_b64_tr_b16 v[190:191], v251 offset:55296
    s_waitcnt vmcnt(3) lgkmcnt(8)
    v_mfma_f32_16x16x32_bf16 v[128:131], v[160:163], v[112:115], v[128:131]
    ds_read_b64_tr_b16 v[192:193], v248 offset:57344
    ds_read_b64_tr_b16 v[194:195], v248 offset:59392
    v_mfma_f32_16x16x32_bf16 v[132:135], v[164:167], v[112:115], v[132:135]
    ds_read_b64_tr_b16 v[196:197], v249 offset:57344
    ds_read_b64_tr_b16 v[198:199], v249 offset:59392
    v_mfma_f32_16x16x32_bf16 v[136:139], v[168:171], v[112:115], v[136:139]
    ds_read_b64_tr_b16 v[200:201], v250 offset:57344
    ds_read_b64_tr_b16 v[202:203], v250 offset:59392
    v_mfma_f32_16x16x32_bf16 v[140:143], v[172:175], v[112:115], v[140:143]
    ds_read_b64_tr_b16 v[204:205], v251 offset:57344
    ds_read_b64_tr_b16 v[206:207], v251 offset:59392
    s_waitcnt vmcnt(2) lgkmcnt(8)
    v_mfma_f32_16x16x32_bf16 v[128:131], v[176:179], v[116:119], v[128:131]
    ds_read_b64_tr_b16 v[160:161], v248 offset:61440
    ds_read_b64_tr_b16 v[162:163], v248 offset:63488
    v_mfma_f32_16x16x32_bf16 v[132:135], v[180:183], v[116:119], v[132:135]
    ds_read_b64_tr_b16 v[164:165], v249 offset:61440
    ds_read_b64_tr_b16 v[166:167], v249 offset:63488
    v_mfma_f32_16x16x32_bf16 v[136:139], v[184:187], v[116:119], v[136:139]
    ds_read_b64_tr_b16 v[168:169], v250 offset:61440
    ds_read_b64_tr_b16 v[170:171], v250 offset:63488
    v_mfma_f32_16x16x32_bf16 v[140:143], v[188:191], v[116:119], v[140:143]
    ds_read_b64_tr_b16 v[172:173], v251 offset:61440
    ds_read_b64_tr_b16 v[174:175], v251 offset:63488
    s_waitcnt vmcnt(1) lgkmcnt(8)
    v_mfma_f32_16x16x32_bf16 v[128:131], v[192:195], v[120:123], v[128:131]
    v_mfma_f32_16x16x32_bf16 v[132:135], v[196:199], v[120:123], v[132:135]
    v_mfma_f32_16x16x32_bf16 v[136:139], v[200:203], v[120:123], v[136:139]
    v_mfma_f32_16x16x32_bf16 v[140:143], v[204:207], v[120:123], v[140:143]
    s_waitcnt vmcnt(0) lgkmcnt(0)
    v_mfma_f32_16x16x32_bf16 v[128:131], v[160:163], v[124:127], v[128:131]
    v_mfma_f32_16x16x32_bf16 v[132:135], v[164:167], v[124:127], v[132:135]
    v_mfma_f32_16x16x32_bf16 v[136:139], v[168:171], v[124:127], v[136:139]
    v_mfma_f32_16x16x32_bf16 v[140:143], v[172:175], v[124:127], v[140:143]
    s_nop 4
    s_nop 0
    v_pk_add_f32 v[128:129], v[128:129], v[224:225]
    v_pk_add_f32 v[130:131], v[130:131], v[226:227]
    v_pk_add_f32 v[132:133], v[132:133], v[228:229]
    v_pk_add_f32 v[134:135], v[134:135], v[230:231]
    v_pk_add_f32 v[136:137], v[136:137], v[232:233]
    v_pk_add_f32 v[138:139], v[138:139], v[234:235]
    v_pk_add_f32 v[140:141], v[140:141], v[236:237]
    v_pk_add_f32 v[142:143], v[142:143], v[238:239]
    v_cvt_pk_bf16_f32 v56, v128, v129
    v_cvt_pk_bf16_f32 v57, v130, v131
    v_cvt_pk_bf16_f32 v58, v132, v133
    v_cvt_pk_bf16_f32 v59, v134, v135
    v_cvt_pk_bf16_f32 v60, v136, v137
    v_cvt_pk_bf16_f32 v61, v138, v139
    v_cvt_pk_bf16_f32 v62, v140, v141
    v_cvt_pk_bf16_f32 v63, v142, v143
    buffer_store_dwordx4 v[56:59], v245, s[24:27], 0 offen sc1
    buffer_store_dwordx4 v[60:63], v245, s[24:27], 0 offen offset:2048 sc1
    v_pk_mul_f32 v[42:43], v[128:129], v[128:129]
    v_pk_add_f32 v[40:41], v[128:129], v[130:131]
    v_pk_fma_f32 v[42:43], v[130:131], v[130:131], v[42:43]
    v_pk_add_f32 v[40:41], v[40:41], v[132:133]
    v_pk_fma_f32 v[42:43], v[132:133], v[132:133], v[42:43]
    v_pk_add_f32 v[40:41], v[40:41], v[134:135]
    v_pk_fma_f32 v[42:43], v[134:135], v[134:135], v[42:43]
    v_pk_add_f32 v[40:41], v[40:41], v[136:137]
    v_pk_fma_f32 v[42:43], v[136:137], v[136:137], v[42:43]
    v_pk_add_f32 v[40:41], v[40:41], v[138:139]
    v_pk_fma_f32 v[42:43], v[138:139], v[138:139], v[42:43]
    v_pk_add_f32 v[40:41], v[40:41], v[140:141]
    v_pk_fma_f32 v[42:43], v[140:141], v[140:141], v[42:43]
    v_pk_add_f32 v[40:41], v[40:41], v[142:143]
    v_pk_fma_f32 v[42:43], v[142:143], v[142:143], v[42:43]
    v_add_f32 v40, v40, v41
    v_add_f32 v41, v42, v43
    v_mov_b32 v42, v40
    v_mov_b32 v43, v41
    s_nop 0
    v_permlane16_swap_b32 v40, v42
    v_permlane16_swap_b32 v41, v43
    v_add_f32 v40, v40, v42
    v_add_f32 v41, v41, v43
    v_mov_b32 v42, v40
    v_mov_b32 v43, v41
    s_nop 0
    v_permlane32_swap_b32 v40, v42
    v_permlane32_swap_b32 v41, v43
    v_add_f32 v40, v40, v42
    v_add_f32 v41, v41, v43
    s_mov_b32 exec_lo, 0xffff
    s_mov_b32 exec_hi, 0
    buffer_store_dwordx2 v[40:41], v246, s[28:31], 0 offen sc1
    s_mov_b64 exec, -1
    v_add_u32 v30, 512, v30
    s_waitcnt lgkmcnt(0)
    s_barrier
    s_add_u32 s61, s37, 131072
    v_add_u32 v10, s61, v8
    ds_read_b64_tr_b16 v[160:161], v10 offset:0
    ds_read_b64_tr_b16 v[162:163], v10 offset:512
    ds_read_b64_tr_b16 v[164:165], v10 offset:1024
    ds_read_b64_tr_b16 v[166:167], v10 offset:1536
    ds_read_b64_tr_b16 v[168:169], v10 offset:2048
    ds_read_b64_tr_b16 v[170:171], v10 offset:2560
    s_add_u32 s61, s37, 143360
    v_add_u32 v11, s61, v8
    ds_read_b64_tr_b16 v[172:173], v11 offset:0
    ds_read_b64_tr_b16 v[174:175], v11 offset:512
    ds_read_b64_tr_b16 v[176:177], v11 offset:1024
    ds_read_b64_tr_b16 v[178:179], v11 offset:1536
    ds_read_b64_tr_b16 v[180:181], v11 offset:2048
    ds_read_b64_tr_b16 v[182:183], v11 offset:2560
    s_add_u32 s61, s37, 0
    v_add_u32 v10, s61, v8
    ds_read_b64_tr_b16 v[184:185], v10 offset:0
    ds_read_b64_tr_b16 v[186:187], v10 offset:512
    ds_read_b64_tr_b16 v[188:189], v10 offset:1024
    ds_read_b64_tr_b16 v[190:191], v10 offset:1536
    ds_read_b64_tr_b16 v[192:193], v10 offset:2048
    ds_read_b64_tr_b16 v[194:195], v10 offset:2560
    s_waitcnt lgkmcnt(12)
    s_nop 0
    v_dot2_f32_bf16 v144, v160, v24, 0
    v_dot2_f32_bf16 v146, v164, v24, 0
    v_dot2_f32_bf16 v148, v168, v24, 0
    v_dot2_f32_bf16 v145, v161, v24, 0
    v_dot2_f32_bf16 v147, v165, v24, 0
    v_dot2_f32_bf16 v149, v169, v24, 0
    v_dot2_f32_bf16 v144, v162, v24, v144
    v_dot2_f32_bf16 v146, v166, v24, v146
    v_dot2_f32_bf16 v148, v170, v24, v148
    v_dot2_f32_bf16 v145, v163, v24, v145
    v_dot2_f32_bf16 v147, v167, v24, v147
    v_dot2_f32_bf16 v149, v171, v24, v149
    s_waitcnt lgkmcnt(6)
    s_nop 0
    v_dot2_f32_bf16 v144, v172, v24, v144
    v_dot2_f32_bf16 v146, v176, v24, v146
    v_dot2_f32_bf16 v148, v180, v24, v148
    v_dot2_f32_bf16 v145, v173, v24, v145
    v_dot2_f32_bf16 v147, v177, v24, v147
    v_dot2_f32_bf16 v149, v181, v24, v149
    v_dot2_f32_bf16 v144, v174, v24, v144
    v_dot2_f32_bf16 v146, v178, v24, v146
    v_dot2_f32_bf16 v148, v182, v24, v148
    v_dot2_f32_bf16 v145, v175, v24, v145
    v_dot2_f32_bf16 v147, v179, v24, v147
    v_dot2_f32_bf16 v149, v183, v24, v149
    s_waitcnt lgkmcnt(0)
    s_nop 0
    v_dot2_f32_bf16 v144, v184, v24, v144
    v_dot2_f32_bf16 v146, v188, v24, v146
    v_dot2_f32_bf16 v148, v192, v24, v148
    v_dot2_f32_bf16 v145, v185, v24, v145
    v_dot2_f32_bf16 v147, v189, v24, v147
    v_dot2_f32_bf16 v149, v193, v24, v149
    v_dot2_f32_bf16 v144, v186, v24, v144
    v_dot2_f32_bf16 v146, v190, v24, v146
    v_dot2_f32_bf16 v148, v194, v24, v148
    v_dot2_f32_bf16 v145, v187, v24, v145
    v_dot2_f32_bf16 v147, v191, v24, v147
    v_dot2_f32_bf16 v149, v195, v24, v149
    v_mov_b32 v28, s50
    v_mov_b32 v29, s51
    s_waitcnt vmcnt(0)
    s_mov_b64 exec, 1
    s_cmp_eq_u32 s57, 0
    s_cbranch_scc1 Lslow12
    buffer_store_dwordx2 v[28:29], v30, s[28:31], 0 offen
    s_branch Ldone13
Lslow12:
    buffer_store_dwordx2 v[28:29], v30, s[28:31], 0 offen sc1
Ldone13:
    s_mov_b64 exec, -1
    s_add_u32 s61, s37, 12288
    v_add_u32 v10, s61, v8
    ds_read_b64_tr_b16 v[160:161], v10 offset:0
    ds_read_b64_tr_b16 v[162:163], v10 offset:512
    ds_read_b64_tr_b16 v[164:165], v10 offset:1024
    ds_read_b64_tr_b16 v[166:167], v10 offset:1536
    ds_read_b64_tr_b16 v[168:169], v10 offset:2048
    ds_read_b64_tr_b16 v[170:171], v10 offset:2560
    s_add_u32 s61, s37, 24576
    v_add_u32 v11, s61, v8
    ds_read_b64_tr_b16 v[172:173], v11 offset:0
    ds_read_b64_tr_b16 v[174:175], v11 offset:512
    ds_read_b64_tr_b16 v[176:177], v11 offset:1024
    ds_read_b64_tr_b16 v[178:179], v11 offset:1536
    ds_read_b64_tr_b16 v[180:181], v11 offset:2048
    ds_read_b64_tr_b16 v[182:183], v11 offset:2560
    s_add_u32 s61, s37, 36864
    v_add_u32 v10, s61, v8
    ds_read_b64_tr_b16 v[184:185], v10 offset:0
    ds_read_b64_tr_b16 v[186:187], v10 offset:512
    ds_read_b64_tr_b16 v[188:189], v10 offset:1024
    ds_read_b64_tr_b16 v[190:191], v10 offset:1536
    ds_read_b64_tr_b16 v[192:193], v10 offset:2048
    ds_read_b64_tr_b16 v[194:195], v10 offset:2560
    s_waitcnt lgkmcnt(12)
    v_dot2_f32_bf16 v144, v160, v24, v144
    v_dot2_f32_bf16 v146, v164, v24, v146
    v_dot2_f32_bf16 v148, v168, v24, v148
    v_dot2_f32_bf16 v145, v161, v24, v145
    v_dot2_f32_bf16 v147, v165, v24, v147
    v_dot2_f32_bf16 v149, v169, v24, v149
    v_dot2_f32_bf16 v144, v162, v24, v144
    v_dot2_f32_bf16 v146, v166, v24, v146
    v_dot2_f32_bf16 v148, v170, v24, v148
    v_dot2_f32_bf16 v145, v163, v24, v145
    v_dot2_f32_bf16 v147, v167, v24, v147
    v_dot2_f32_bf16 v149, v171, v24, v149
    s_add_u32 s61, s37, 49152
    v_add_u32 v11, s61, v8
    ds_read_b64_tr_b16 v[196:197], v11 offset:0
    ds_read_b64_tr_b16 v[198:199], v11 offset:512
    ds_read_b64_tr_b16 v[200:201], v11 offset:1024
    ds_read_b64_tr_b16 v[202:203], v11 offset:1536
    ds_read_b64_tr_b16 v[204:205], v11 offset:2048
    ds_read_b64_tr_b16 v[206:207], v11 offset:2560
    s_waitcnt lgkmcnt(12)
    v_dot2_f32_bf16 v144, v172, v24, v144
    v_dot2_f32_bf16 v146, v176, v24, v146
    v_dot2_f32_bf16 v148, v180, v24, v148
    v_dot2_f32_bf16 v145, v173, v24, v145
    v_dot2_f32_bf16 v147, v177, v24, v147
    v_dot2_f32_bf16 v149, v181, v24, v149
    v_dot2_f32_bf16 v144, v174, v24, v144
    v_dot2_f32_bf16 v146, v178, v24, v146
    v_dot2_f32_bf16 v148, v182, v24, v148
    v_dot2_f32_bf16 v145, v175, v24, v145
    v_dot2_f32_bf16 v147, v179, v24, v147
    v_dot2_f32_bf16 v149, v183, v24, v149
    s_add_u32 s59, s37, 152576
    s_cmp_eq_u32 s56, 0
    s_cselect_b32 s61, 61440, s59
    v_add_u32 v10, s61, v8
    ds_read_b64_tr_b16 v[160:161], v10 offset:0
    ds_read_b64_tr_b16 v[162:163], v10 offset:512
    ds_read_b64_tr_b16 v[164:165], v10 offset:1024
    ds_read_b64_tr_b16 v[166:167], v10 offset:1536
    s_cmp_eq_u32 s56, 3
    s_cselect_b32 s61, 62464, s61
    v_add_u32 v10, s61, v8
    ds_read_b64_tr_b16 v[168:169], v10 offset:2048
    ds_read_b64_tr_b16 v[170:171], v10 offset:2560
    s_waitcnt lgkmcnt(12)
    s_nop 0
    v_dot2_f32_bf16 v144, v184, v24, v144
    v_dot2_f32_bf16 v146, v188, v24, v146
    v_dot2_f32_bf16 v148, v192, v24, v148
    v_dot2_f32_bf16 v145, v185, v24, v145
    v_dot2_f32_bf16 v147, v189, v24, v147
    v_dot2_f32_bf16 v149, v193, v24, v149
    v_dot2_f32_bf16 v144, v186, v24, v144
    v_dot2_f32_bf16 v146, v190, v24, v146
    v_dot2_f32_bf16 v148, v194, v24, v148
    v_dot2_f32_bf16 v145, v187, v24, v145
    v_dot2_f32_bf16 v147, v191, v24, v147
    v_dot2_f32_bf16 v149, v195, v24, v149
    s_waitcnt lgkmcnt(6)
    s_nop 0
    v_dot2_f32_bf16 v144, v196, v24, v144
    v_dot2_f32_bf16 v146, v200, v24, v146
    v_dot2_f32_bf16 v148, v204, v24, v148
    v_dot2_f32_bf16 v145, v197, v24, v145
    v_dot2_f32_bf16 v147, v201, v24, v147
    v_dot2_f32_bf16 v149, v205, v24, v149
    v_dot2_f32_bf16 v144, v198, v24, v144
    v_dot2_f32_bf16 v146, v202, v24, v146
    v_dot2_f32_bf16 v148, v206, v24, v148
    v_dot2_f32_bf16 v145, v199, v24, v145
    v_dot2_f32_bf16 v147, v203, v24, v147
    v_dot2_f32_bf16 v149, v207, v24, v149
    s_waitcnt lgkmcnt(0)
    s_nop 0
    v_dot2_f32_bf16 v144, v160, v24, v144
    v_dot2_f32_bf16 v146, v164, v24, v146
    v_dot2_f32_bf16 v148, v168, v24, v148
    v_dot2_f32_bf16 v145, v161, v24, v145
    v_dot2_f32_bf16 v147, v165, v24, v147
    v_dot2_f32_bf16 v149, v169, v24, v149
    v_dot2_f32_bf16 v144, v162, v24, v144
    v_dot2_f32_bf16 v146, v166, v24, v146
    v_dot2_f32_bf16 v148, v170, v24, v148
    v_dot2_f32_bf16 v145, v163, v24, v145
    v_dot2_f32_bf16 v147, v167, v24, v147
    v_dot2_f32_bf16 v149, v171, v24, v149
    s_nop 0
    v_add_f32 v144, v144, v145
    v_add_f32 v146, v146, v147
    v_add_f32 v148, v148, v149
    v_mov_b32 v47, v144
    s_nop 1
    v_permlane32_swap_b32 v144, v47
    v_add_f32 v144, v144, v47
    v_mov_b32 v47, v146
    s_nop 1
    v_permlane32_swap_b32 v146, v47
    v_add_f32 v146, v146, v47
    v_mov_b32 v47, v148
    s_nop 1
    v_permlane32_swap_b32 v148, v47
    v_add_f32 v148, v148, v47
    v_and_b32 v40, 31, v1
    v_lshlrev_b32 v40, 4, v40
    v_add_u32 v45, 77824, v40
    s_lshl_b32 s59, s56, 2
    v_add_u32 v40, s59, v45
    s_mov_b32 exec_hi, 0
    ds_write_b32 v40, v144 offset:0
    ds_write_b32 v40, v146 offset:512
    ds_write_b32 v40, v148 offset:1024
    s_mov_b64 exec, -1
    buffer_load_dwordx2 v[28:29], v4, s[28:31], 0 offen sc1
    s_waitcnt lgkmcnt(0)
    s_barrier
    ds_read_b128 v[48:51], v45 offset:0
    ds_read_b128 v[52:55], v45 offset:512
    ds_read_b128 v[56:59], v45 offset:1024
    v_and_b32 v40, 31, v1
    v_lshlrev_b32 v40, 2, v40
    v_add_u32 v40, 79360, v40
    s_waitcnt lgkmcnt(0)
    v_add_f32 v48, v48, v49
    v_add_f32 v50, v50, v51
    v_add_f32 v52, v52, v53
    v_add_f32 v54, v54, v55
    v_add_f32 v56, v56, v57
    v_add_f32 v58, v58, v59
    v_add_f32 v48, v48, v50
    v_add_f32 v52, v52, v54
    v_add_f32 v56, v56, v58
    ds_write_b32 v40, v48 offset:0
    ds_write_b32 v40, v52 offset:128
    ds_write_b32 v40, v56 offset:256
    v_lshrrev_b32 v47, 5, v1
    v_lshlrev_b32 v47, 4, v47
    v_add_u32 v47, 79360, v47
    ds_read_b128 v[112:115], v47 offset:0
    ds_read_b128 v[116:119], v47 offset:32
    ds_read_b128 v[120:123], v47 offset:64
    ds_read_b128 v[124:127], v47 offset:96
    ds_read_b128 v[128:131], v47 offset:128
    ds_read_b128 v[132:135], v47 offset:160
    ds_read_b128 v[136:139], v47 offset:192
    ds_read_b128 v[140:143], v47 offset:224
    ds_read_b128 v[144:147], v47 offset:256
    ds_read_b128 v[148:151], v47 offset:288
    ds_read_b128 v[152:155], v47 offset:320
    ds_read_b128 v[156:159], v47 offset:352
    s_mov_b32 s80, 0
Lpoll14:
    s_waitcnt vmcnt(0)
    v_cmp_ne_u64 vcc, s[50:51], v[28:29]
    s_cbranch_vccz Lpollok15
    s_add_u32 s80, s80, 1
    s_cmp_gt_u32 s80, 0x40000
    s_cbranch_scc1 Lpollok15
    s_cmp_lg_u32 s57, 0
    s_cbranch_scc1 Lnosleep16
    s_sleep 8
Lnosleep16:
    buffer_load_dwordx2 v[28:29], v4, s[28:31], 0 offen sc1
    s_branch Lpoll14
Lpollok15:
    s_mov_b32 s78, 0
    buffer_load_dwordx4 v[196:199], v14, s[24:27], s78 offen offset:0 sc1
    v_lshrrev_b32 v40, 5, v1
    v_bfe_u32 v41, v1, 2, 2
    v_lshl_add_u32 v42, v40, 3, v41
    v_lshlrev_b32 v42, 7, v42
    v_bfe_u32 v43, v1, 4, 1
    v_lshl_add_u32 v42, v43, 5, v42
    v_and_b32 v43, 1, v1
    v_lshl_add_u32 v42, v43, 4, v42
    buffer_load_dwordx4 v[200:203], v14, s[24:27], s78 offen offset:1024 sc1
    v_bfe_u32 v43, v1, 1, 1
    v_lshl_add_u32 v48, v43, 3, v42
    v_bfe_u32 v41, v1, 3, 1
    v_lshlrev_b32 v41, 6, v41
    s_lshl_b32 s60, s38, 6
    v_xor_b32 v41, s60, v41
    v_add_u32 v42, v48, v41
    v_xor_b32 v41, 64, v41
    buffer_load_dwordx4 v[204:207], v14, s[24:27], s78 offen offset:2048 sc1
    v_add_u32 v43, v48, v41
    s_lshl_b32 s60, s38, 15
    s_add_u32 s59, s60, 65536
    v_add_u32 v248, s59, v42
    v_add_u32 v249, s59, v43
    v_add_u32 v250, s60, v42
    v_add_u32 v251, s60, v43
    s_lshl_b32 s60, s38, 14
    buffer_load_dwordx4 v[208:211], v14, s[24:27], s78 offen offset:3072 sc1
    s_add_u32 s59, s60, 131072
    v_add_u32 v252, s59, v42
    v_add_u32 v253, s59, v43
    s_and_b32 s59, s54, 1
    s_lshl_b32 s59, s59, 1
    s_add_u32 s59, s59, s39
    s_lshl_b32 s43, s52, 2
    s_add_u32 s43, s43, s59
    s_mov_b32 s78, 4096
    buffer_load_dwordx4 v[212:215], v14, s[24:27], s78 offen offset:0 sc1
    s_lshl_b32 s59, s59, 7
    s_lshl_b32 s60, s52, 12
    s_add_u32 s59, s59, s60
    s_add_u32 s59, s59, 1024
    v_and_b32 v40, 15, v1
    v_lshlrev_b32 v40, 3, v40
    v_add_u32 v244, s59, v40
    s_mul_i32 s59, s43, 88064
    buffer_load_dwordx4 v[216:219], v14, s[24:27], s78 offen offset:1024 sc1
    s_mul_i32 s60, s38, 44032
    s_add_u32 s59, s59, s60
    s_add_u32 s59, s59, 5242880
    v_lshlrev_b32 v40, 4, v1
    v_add_u32 v246, s59, v40
    s_lshl_b32 s59, s56, 12
    s_add_u32 s60, s59, 73728
    s_xor_b32 s59, s59, 8192
    buffer_load_dwordx4 v[220:223], v14, s[24:27], s78 offen offset:2048 sc1
    s_add_u32 s59, s59, 73728
    v_add_u32 v254, s60, v40
    v_add_u32 v255, s59, v40
    s_lshl_b32 s59, s43, 15
    s_lshl_b32 s60, s55, 1
    s_add_u32 s60, s60, s38
    s_lshl_b32 s60, s60, 11
    s_add_u32 s59, s59, s60
    buffer_load_dwordx4 v[224:227], v14, s[24:27], s78 offen offset:3072 sc1
    v_lshrrev_b32 v40, 5, v1
    v_lshlrev_b32 v40, 10, v40
    v_and_b32 v41, 31, v1
    v_lshl_add_u32 v40, v41, 4, v40
    v_add_u32 v247, s59, v40
    s_lshl_b32 s59, s43, 15
    s_lshl_b32 s60, s55, 7
    s_add_u32 s59, s59, s60
    s_mov_b32 s78, 8192
    buffer_load_dwordx4 v[228:231], v14, s[24:27], s78 offen offset:0 sc1
    s_lshl_b32 s60, s38, 6
    s_add_u32 s59, s59, s60
    v_lshlrev_b32 v44, 10, v41
    v_lshrrev_b32 v45, 5, v1
    v_lshl_add_u32 v44, v45, 4, v44
    v_add_u32 v245, s59, v44
    ds_read_b64_tr_b16 v[160:161], v9 offset:0
    ds_read_b64_tr_b16 v[162:163], v9 offset:512
    ds_read_b64_tr_b16 v[164:165], v9 offset:1024
    ds_read_b64_tr_b16 v[166:167], v9 offset:1536
    ds_read_b64_tr_b16 v[168:169], v9 offset:2048
    ds_read_b64_tr_b16 v[170:171], v9 offset:2560
    ds_read_b64_tr_b16 v[172:173], v9 offset:3072
    ds_read_b64_tr_b16 v[174:175], v9 offset:3584
    ds_read_b64_tr_b16 v[176:177], v9 offset:4096
    ds_read_b64_tr_b16 v[178:179], v9 offset:4608
    ds_read_b64_tr_b16 v[180:181], v9 offset:5120
    ds_read_b64_tr_b16 v[182:183], v9 offset:5632
    s_waitcnt vmcnt(8) lgkmcnt(6)
    v_mfma_f32_32x32x16_bf16 v[64:79], v[160:163], v[196:199], 0
    ds_read_b64_tr_b16 v[184:185], v9 offset:6144
    ds_read_b64_tr_b16 v[186:187], v9 offset:6656
    v_mfma_f32_32x32x16_bf16 v[80:95], v[164:167], v[196:199], 0
    ds_read_b64_tr_b16 v[188:189], v9 offset:7168
    ds_read_b64_tr_b16 v[190:191], v9 offset:7680
    v_mfma_f32_32x32x16_bf16 v[96:111], v[168:171], v[196:199], 0
    ds_read_b64_tr_b16 v[192:193], v9 offset:8192
    ds_read_b64_tr_b16 v[194:195], v9 offset:8704
    buffer_load_dwordx4 v[232:235], v14, s[24:27], s78 offen offset:1024 sc1
    s_waitcnt vmcnt(8) lgkmcnt(6)
    v_mfma_f32_32x32x16_bf16 v[64:79], v[172:175], v[200:203], v[64:79]
    ds_read_b64_tr_b16 v[160:161], v9 offset:9216
    ds_read_b64_tr_b16 v[162:163], v9 offset:9728
    v_mfma_f32_32x32x16_bf16 v[80:95], v[176:179], v[200:203], v[80:95]
    ds_read_b64_tr_b16 v[164:165], v9 offset:10240
    ds_read_b64_tr_b16 v[166:167], v9 offset:10752
    v_mfma_f32_32x32x16_bf16 v[96:111], v[180:183], v[200:203], v[96:111]
    ds_read_b64_tr_b16 v[168:169], v9 offset:11264
    ds_read_b64_tr_b16 v[170:171], v9 offset:11776
    buffer_load_dwordx4 v[236:239], v14, s[24:27], s78 offen offset:2048 sc1
    s_mov_b32 s60, 0
    buffer_load_dwordx2 v[48:49], v6, s[28:31], s60 offen sc1
    s_waitcnt vmcnt(9) lgkmcnt(6)
    v_mfma_f32_32x32x16_bf16 v[64:79], v[184:187], v[204:207], v[64:79]
    ds_read_b64_tr_b16 v[172:173], v9 offset:12288
    ds_read_b64_tr_b16 v[174:175], v9 offset:12800
    v_mfma_f32_32x32x16_bf16 v[80:95], v[188:191], v[204:207], v[80:95]
    ds_read_b64_tr_b16 v[176:177], v9 offset:13312
    ds_read_b64_tr_b16 v[178:179], v9 offset:13824
    v_mfma_f32_32x32x16_bf16 v[96:111], v[192:195], v[204:207], v[96:111]
    ds_read_b64_tr_b16 v[180:181], v9 offset:14336
    ds_read_b64_tr_b16 v[182:183], v9 offset:14848
    buffer_load_dwordx4 v[240:243], v14, s[24:27], s78 offen offset:3072 sc1
    s_mov_b32 s60, 16384
    buffer_load_dwordx2 v[50:51], v6, s[28:31], s60 offen sc1
    s_waitcnt vmcnt(10) lgkmcnt(6)
    v_mfma_f32_32x32x16_bf16 v[64:79], v[160:163], v[208:211], v[64:79]
    ds_read_b64_tr_b16 v[184:185], v9 offset:15360
    ds_read_b64_tr_b16 v[186:187], v9 offset:15872
    v_mfma_f32_32x32x16_bf16 v[80:95], v[164:167], v[208:211], v[80:95]
    ds_read_b64_tr_b16 v[188:189], v9 offset:16384
    ds_read_b64_tr_b16 v[190:191], v9 offset:16896
    v_mfma_f32_32x32x16_bf16 v[96:111], v[168:171], v[208:211], v[96:111]
    ds_read_b64_tr_b16 v[192:193], v9 offset:17408
    ds_read_b64_tr_b16 v[194:195], v9 offset:17920
    s_mov_b32 s78, 12288
    buffer_load_dwordx4 v[196:199], v14, s[24:27], s78 offen offset:0 sc1
    s_mov_b32 s60, 32768
    buffer_load_dwordx2 v[52:53], v6, s[28:31], s60 offen sc1
    s_waitcnt vmcnt(11) lgkmcnt(6)
    v_mfma_f32_32x32x16_bf16 v[64:79], v[172:175], v[212:215], v[64:79]
    ds_read_b64_tr_b16 v[160:161], v9 offset:18432
    ds_read_b64_tr_b16 v[162:163], v9 offset:18944
    v_mfma_f32_32x32x16_bf16 v[80:95], v[176:179], v[212:215], v[80:95]
    ds_read_b64_tr_b16 v[164:165], v9 offset:19456
    ds_read_b64_tr_b16 v[166:167], v9 offset:19968
    v_mfma_f32_32x32x16_bf16 v[96:111], v[180:183], v[212:215], v[96:111]
    ds_read_b64_tr_b16 v[168:169], v9 offset:20480
    ds_read_b64_tr_b16 v[170:171], v9 offset:20992
    buffer_load_dwordx4 v[200:203], v14, s[24:27], s78 offen offset:1024 sc1
    s_mov_b32 s60, 49152
    buffer_load_dwordx2 v[54:55], v6, s[28:31], s60 offen sc1
    s_waitcnt vmcnt(12) lgkmcnt(6)
    v_mfma_f32_32x32x16_bf16 v[64:79], v[184:187], v[216:219], v[64:79]
    ds_read_b64_tr_b16 v[172:173], v9 offset:21504
    ds_read_b64_tr_b16 v[174:175], v9 offset:22016
    v_mfma_f32_32x32x16_bf16 v[80:95], v[188:191], v[216:219], v[80:95]
    ds_read_b64_tr_b16 v[176:177], v9 offset:22528
    ds_read_b64_tr_b16 v[178:179], v9 offset:23040
    v_mfma_f32_32x32x16_bf16 v[96:111], v[192:195], v[216:219], v[96:111]
    ds_read_b64_tr_b16 v[180:181], v9 offset:23552
    ds_read_b64_tr_b16 v[182:183], v9 offset:24064
    buffer_load_dwordx4 v[204:207], v14, s[24:27], s78 offen offset:2048 sc1
    s_waitcnt vmcnt(12) lgkmcnt(6)
    v_mfma_f32_32x32x16_bf16 v[64:79], v[160:163], v[220:223], v[64:79]
    ds_read_b64_tr_b16 v[184:185], v8 offset:0
    ds_read_b64_tr_b16 v[186:187], v8 offset:512
    v_mfma_f32_32x32x16_bf16 v[80:95], v[164:167], v[220:223], v[80:95]
    ds_read_b64_tr_b16 v[188:189], v8 offset:1024
    ds_read_b64_tr_b16 v[190:191], v8 offset:1536
    v_mfma_f32_32x32x16_bf16 v[96:111], v[168:171], v[220:223], v[96:111]
    ds_read_b64_tr_b16 v[192:193], v8 offset:2048
    ds_read_b64_tr_b16 v[194:195], v8 offset:2560
    buffer_load_dwordx4 v[208:211], v14, s[24:27], s78 offen offset:3072 sc1
    s_waitcnt vmcnt(12) lgkmcnt(6)
    v_mfma_f32_32x32x16_bf16 v[64:79], v[172:175], v[224:227], v[64:79]
    ds_read_b64_tr_b16 v[160:161], v8 offset:3072
    ds_read_b64_tr_b16 v[162:163], v8 offset:3584
    v_mfma_f32_32x32x16_bf16 v[80:95], v[176:179], v[224:227], v[80:95]
    ds_read_b64_tr_b16 v[164:165], v8 offset:4096
    ds_read_b64_tr_b16 v[166:167], v8 offset:4608
    v_mfma_f32_32x32x16_bf16 v[96:111], v[180:183], v[224:227], v[96:111]
    ds_read_b64_tr_b16 v[168:169], v8 offset:5120
    ds_read_b64_tr_b16 v[170:171], v8 offset:5632
    s_mov_b32 s78, 16384
    buffer_load_dwordx4 v[212:215], v14, s[24:27], s78 offen offset:0 sc1
    s_barrier
    s_waitcnt vmcnt(12) lgkmcnt(6)
    v_mfma_f32_32x32x16_bf16 v[64:79], v[184:187], v[228:231], v[64:79]
    ds_read_b64_tr_b16 v[172:173], v8 offset:6144
    ds_read_b64_tr_b16 v[174:175], v8 offset:6656
    v_mfma_f32_32x32x16_bf16 v[80:95], v[188:191], v[228:231], v[80:95]
    ds_read_b64_tr_b16 v[176:177], v8 offset:7168
    ds_read_b64_tr_b16 v[178:179], v8 offset:7680
    v_mfma_f32_32x32x16_bf16 v[96:111], v[192:195], v[228:231], v[96:111]
    ds_read_b64_tr_b16 v[180:181], v8 offset:8192
    ds_read_b64_tr_b16 v[182:183], v8 offset:8704
    buffer_load_dwordx4 v[216:219], v14, s[24:27], s78 offen offset:1024 sc1
    s_lshl_b32 s59, s43, 8
    s_add_u32 s59, s59, 65536
    v_and_b32 v40, 31, v1
    v_lshlrev_b32 v40, 3, v40
    v_lshrrev_b32 v41, 5, v1
    v_lshl_add_u32 v40, v41, 16, v40
    v_add_u32 v6, s59, v40
    s_waitcnt vmcnt(12) lgkmcnt(6)
    v_mfma_f32_32x32x16_bf16 v[64:79], v[160:163], v[232:235], v[64:79]
    ds_read_b64_tr_b16 v[184:185], v8 offset:9216
    ds_read_b64_tr_b16 v[186:187], v8 offset:9728
    v_mfma_f32_32x32x16_bf16 v[80:95], v[164:167], v[232:235], v[80:95]
    ds_read_b64_tr_b16 v[188:189], v8 offset:10240
    ds_read_b64_tr_b16 v[190:191], v8 offset:10752
    v_mfma_f32_32x32x16_bf16 v[96:111], v[168:171], v[232:235], v[96:111]
    ds_read_b64_tr_b16 v[192:193], v8 offset:11264
    ds_read_b64_tr_b16 v[194:195], v8 offset:11776
    buffer_load_dwordx4 v[220:223], v14, s[24:27], s78 offen offset:2048 sc1
    s_mov_b32 s60, 0
    buffer_load_dwordx2 v[56:57], v6, s[28:31], s60 offen sc1
    s_waitcnt vmcnt(13) lgkmcnt(6)
    v_mfma_f32_32x32x16_bf16 v[64:79], v[172:175], v[236:239], v[64:79]
    ds_read_b64_tr_b16 v[160:161], v8 offset:12288
    ds_read_b64_tr_b16 v[162:163], v8 offset:12800
    v_mfma_f32_32x32x16_bf16 v[80:95], v[176:179], v[236:239], v[80:95]
    ds_read_b64_tr_b16 v[164:165], v8 offset:13312
    ds_read_b64_tr_b16 v[166:167], v8 offset:13824
    v_mfma_f32_32x32x16_bf16 v[96:111], v[180:183], v[236:239], v[96:111]
    ds_read_b64_tr_b16 v[168:169], v8 offset:14336
    ds_read_b64_tr_b16 v[170:171], v8 offset:14848
    buffer_load_dwordx4 v[224:227], v14, s[24:27], s78 offen offset:3072 sc1
    s_mov_b32 s60, 16384
    buffer_load_dwordx2 v[58:59], v6, s[28:31], s60 offen sc1
    s_waitcnt vmcnt(13) lgkmcnt(6)
    v_mfma_f32_32x32x16_bf16 v[64:79], v[184:187], v[240:243], v[64:79]
    ds_read_b64_tr_b16 v[172:173], v8 offset:15360
    ds_read_b64_tr_b16 v[174:175], v8 offset:15872
    v_mfma_f32_32x32x16_bf16 v[80:95], v[188:191], v[240:243], v[80:95]
    ds_read_b64_tr_b16 v[176:177], v8 offset:16384
    ds_read_b64_tr_b16 v[178:179], v8 offset:16896
    v_mfma_f32_32x32x16_bf16 v[96:111], v[192:195], v[240:243], v[96:111]
    ds_read_b64_tr_b16 v[180:181], v8 offset:17408
    ds_read_b64_tr_b16 v[182:183], v8 offset:17920
    s_mov_b32 s78, 20480
    buffer_load_dwordx4 v[228:231], v14, s[24:27], s78 offen offset:0 sc1
    s_mov_b32 s60, 32768
    buffer_load_dwordx2 v[60:61], v6, s[28:31], s60 offen sc1
    s_waitcnt vmcnt(13) lgkmcnt(6)
    v_mfma_f32_32x32x16_bf16 v[64:79], v[160:163], v[196:199], v[64:79]
    ds_read_b64_tr_b16 v[184:185], v8 offset:18432
    ds_read_b64_tr_b16 v[186:187], v8 offset:18944
    v_mfma_f32_32x32x16_bf16 v[80:95], v[164:167], v[196:199], v[80:95]
    ds_read_b64_tr_b16 v[188:189], v8 offset:19456
    ds_read_b64_tr_b16 v[190:191], v8 offset:19968
    v_mfma_f32_32x32x16_bf16 v[96:111], v[168:171], v[196:199], v[96:111]
    ds_read_b64_tr_b16 v[192:193], v8 offset:20480
    ds_read_b64_tr_b16 v[194:195], v8 offset:20992
    buffer_load_dwordx4 v[232:235], v14, s[24:27], s78 offen offset:1024 sc1
    s_mov_b32 s60, 49152
    buffer_load_dwordx2 v[62:63], v6, s[28:31], s60 offen sc1
    s_waitcnt vmcnt(13) lgkmcnt(6)
    v_mfma_f32_32x32x16_bf16 v[64:79], v[172:175], v[200:203], v[64:79]
    ds_read_b64_tr_b16 v[160:161], v8 offset:21504
    ds_read_b64_tr_b16 v[162:163], v8 offset:22016
    v_mfma_f32_32x32x16_bf16 v[80:95], v[176:179], v[200:203], v[80:95]
    ds_read_b64_tr_b16 v[164:165], v8 offset:22528
    ds_read_b64_tr_b16 v[166:167], v8 offset:23040
    v_mfma_f32_32x32x16_bf16 v[96:111], v[180:183], v[200:203], v[96:111]
    ds_read_b64_tr_b16 v[168:169], v8 offset:23552
    ds_read_b64_tr_b16 v[170:171], v8 offset:24064
    buffer_load_dwordx4 v[236:239], v14, s[24:27], s78 offen offset:2048 sc1
    buffer_load_dwordx4 v[16:19], v247, s[24:27], 0 offen sc1
    s_waitcnt vmcnt(14)
    s_waitcnt vmcnt(13) lgkmcnt(6)
    v_mfma_f32_32x32x16_bf16 v[64:79], v[184:187], v[204:207], v[64:79]
    ds_read_b64_tr_b16 v[172:173], v8 offset:24576
    ds_read_b64_tr_b16 v[174:175], v8 offset:25088
    v_add_f32 v48, v48, v50
    v_mfma_f32_32x32x16_bf16 v[80:95], v[188:191], v[204:207], v[80:95]
    ds_read_b64_tr_b16 v[176:177], v8 offset:25600
    ds_read_b64_tr_b16 v[178:179], v8 offset:26112
    v_add_f32 v49, v49, v51
    v_mfma_f32_32x32x16_bf16 v[96:111], v[192:195], v[204:207], v[96:111]
    ds_read_b64_tr_b16 v[180:181], v8 offset:26624
    ds_read_b64_tr_b16 v[182:183], v8 offset:27136
    v_add_f32 v52, v52, v54
    buffer_load_dwordx4 v[240:243], v14, s[24:27], s78 offen offset:3072 sc1
    buffer_load_dwordx4 v[20:23], v247, s[24:27], 0 offen offset:512 sc1
    s_waitcnt vmcnt(14) lgkmcnt(6)
    v_mfma_f32_32x32x16_bf16 v[64:79], v[160:163], v[208:211], v[64:79]
    ds_read_b64_tr_b16 v[184:185], v8 offset:27648
    ds_read_b64_tr_b16 v[186:187], v8 offset:28160
    v_add_f32 v53, v53, v55
    v_mfma_f32_32x32x16_bf16 v[80:95], v[164:167], v[208:211], v[80:95]
    ds_read_b64_tr_b16 v[188:189], v8 offset:28672
    ds_read_b64_tr_b16 v[190:191], v8 offset:29184
    v_add_f32 v48, v48, v52
    v_mfma_f32_32x32x16_bf16 v[96:111], v[168:171], v[208:211], v[96:111]
    ds_read_b64_tr_b16 v[192:193], v8 offset:29696
    ds_read_b64_tr_b16 v[194:195], v8 offset:30208
    v_add_f32 v49, v49, v53
    s_mov_b32 s78, 24576
    buffer_load_dwordx4 v[196:199], v14, s[24:27], s78 offen offset:0 sc1
    s_waitcnt vmcnt(14) lgkmcnt(6)
    v_mfma_f32_32x32x16_bf16 v[64:79], v[172:175], v[212:215], v[64:79]
    ds_read_b64_tr_b16 v[160:161], v8 offset:30720
    ds_read_b64_tr_b16 v[162:163], v8 offset:31232
    v_mov_b32 v50, v48
    v_mfma_f32_32x32x16_bf16 v[80:95], v[176:179], v[212:215], v[80:95]
    ds_read_b64_tr_b16 v[164:165], v8 offset:31744
    ds_read_b64_tr_b16 v[166:167], v8 offset:32256
    v_mov_b32 v51, v49
    v_mfma_f32_32x32x16_bf16 v[96:111], v[180:183], v[212:215], v[96:111]
    ds_read_b64_tr_b16 v[168:169], v8 offset:32768
    ds_read_b64_tr_b16 v[170:171], v8 offset:33280
    v_permlane32_swap_b32 v48, v50
    buffer_load_dwordx4 v[200:203], v14, s[24:27], s78 offen offset:1024 sc1
    s_waitcnt vmcnt(14) lgkmcnt(6)
    v_mfma_f32_32x32x16_bf16 v[64:79], v[184:187], v[216:219], v[64:79]
    ds_read_b64_tr_b16 v[172:173], v8 offset:33792
    ds_read_b64_tr_b16 v[174:175], v8 offset:34304
    v_permlane32_swap_b32 v49, v51
    v_mfma_f32_32x32x16_bf16 v[80:95], v[188:191], v[216:219], v[80:95]
    ds_read_b64_tr_b16 v[176:177], v8 offset:34816
    ds_read_b64_tr_b16 v[178:179], v8 offset:35328
    v_add_f32 v48, v48, v50
    v_mfma_f32_32x32x16_bf16 v[96:111], v[192:195], v[216:219], v[96:111]
    ds_read_b64_tr_b16 v[180:181], v8 offset:35840
    ds_read_b64_tr_b16 v[182:183], v8 offset:36352
    v_add_f32 v49, v49, v51
    buffer_load_dwordx4 v[204:207], v14, s[24:27], s78 offen offset:2048 sc1
    s_waitcnt vmcnt(14) lgkmcnt(6)
    v_mfma_f32_32x32x16_bf16 v[64:79], v[160:163], v[220:223], v[64:79]
    ds_read_b64_tr_b16 v[184:185], v8 offset:36864
    ds_read_b64_tr_b16 v[186:187], v8 offset:37376
    v_mul_f32 v32, 0xbb000000, v48
    v_mfma_f32_32x32x16_bf16 v[80:95], v[164:167], v[220:223], v[80:95]
    ds_read_b64_tr_b16 v[188:189], v8 offset:37888
    ds_read_b64_tr_b16 v[190:191], v8 offset:38400
    v_mul_f32 v49, 0x3b000000, v49
    v_mfma_f32_32x32x16_bf16 v[96:111], v[168:171], v[220:223], v[96:111]
    ds_read_b64_tr_b16 v[192:193], v8 offset:38912
    ds_read_b64_tr_b16 v[194:195], v8 offset:39424
    v_fma_f32 v49, -v32, v32, v49
    buffer_load_dwordx4 v[208:211], v14, s[24:27], s78 offen offset:3072 sc1
    s_waitcnt vmcnt(13) lgkmcnt(6)
    v_mfma_f32_32x32x16_bf16 v[64:79], v[172:175], v[224:227], v[64:79]
    ds_read_b64_tr_b16 v[160:161], v8 offset:39936
    ds_read_b64_tr_b16 v[162:163], v8 offset:40448
    v_max_f32 v49, 0, v49
    v_mfma_f32_32x32x16_bf16 v[80:95], v[176:179], v[224:227], v[80:95]
    ds_read_b64_tr_b16 v[164:165], v8 offset:40960
    ds_read_b64_tr_b16 v[166:167], v8 offset:41472
    v_add_f32 v49, 0x3727c5ac, v49
    v_mfma_f32_32x32x16_bf16 v[96:111], v[180:183], v[224:227], v[96:111]
    ds_read_b64_tr_b16 v[168:169], v8 offset:41984
    ds_read_b64_tr_b16 v[170:171], v8 offset:42496
    v_rsq_f32 v34, v49
    s_mov_b32 s78, 28672
    buffer_load_dwordx4 v[212:215], v14, s[24:27], s78 offen offset:0 sc1
    s_waitcnt vmcnt(12) lgkmcnt(6)
    v_mfma_f32_32x32x16_bf16 v[64:79], v[184:187], v[228:231], v[64:79]
    ds_read_b64_tr_b16 v[172:173], v8 offset:43008
    ds_read_b64_tr_b16 v[174:175], v8 offset:43520
    v_mul_f32 v38, s74, v34
    v_mfma_f32_32x32x16_bf16 v[80:95], v[188:191], v[228:231], v[80:95]
    ds_read_b64_tr_b16 v[176:177], v8 offset:44032
    ds_read_b64_tr_b16 v[178:179], v8 offset:44544
    v_mul_f32 v40, v34, v34
    v_mfma_f32_32x32x16_bf16 v[96:111], v[192:195], v[228:231], v[96:111]
    ds_read_b64_tr_b16 v[180:181], v8 offset:45056
    ds_read_b64_tr_b16 v[182:183], v8 offset:45568
    v_mul_f32 v40, v40, v34
    buffer_load_dwordx4 v[216:219], v14, s[24:27], s78 offen offset:1024 sc1
    s_waitcnt vmcnt(11) lgkmcnt(6)
    v_mfma_f32_32x32x16_bf16 v[64:79], v[160:163], v[232:235], v[64:79]
    ds_read_b64_tr_b16 v[184:185], v8 offset:46080
    ds_read_b64_tr_b16 v[186:187], v8 offset:46592
    v_mul_f32 v2, s76, v40
    v_mfma_f32_32x32x16_bf16 v[80:95], v[164:167], v[232:235], v[80:95]
    ds_read_b64_tr_b16 v[188:189], v8 offset:47104
    ds_read_b64_tr_b16 v[190:191], v8 offset:47616
    v_mfma_f32_32x32x16_bf16 v[96:111], v[168:171], v[232:235], v[96:111]
    ds_read_b64_tr_b16 v[192:193], v8 offset:48128
    ds_read_b64_tr_b16 v[194:195], v8 offset:48640
    buffer_load_dwordx4 v[220:223], v14, s[24:27], s78 offen offset:2048 sc1
    s_waitcnt vmcnt(10) lgkmcnt(6)
    v_mfma_f32_32x32x16_bf16 v[64:79], v[172:175], v[236:239], v[64:79]
    ds_read_b64_tr_b16 v[160:161], v8 offset:49152
    ds_read_b64_tr_b16 v[162:163], v8 offset:49664
    v_mfma_f32_32x32x16_bf16 v[80:95], v[176:179], v[236:239], v[80:95]
    ds_read_b64_tr_b16 v[164:165], v8 offset:50176
    ds_read_b64_tr_b16 v[166:167], v8 offset:50688
    v_mfma_f32_32x32x16_bf16 v[96:111], v[180:183], v[236:239], v[96:111]
    ds_read_b64_tr_b16 v[168:169], v8 offset:51200
    ds_read_b64_tr_b16 v[170:171], v8 offset:51712
    buffer_load_dwordx4 v[224:227], v14, s[24:27], s78 offen offset:3072 sc1
    s_waitcnt vmcnt(9) lgkmcnt(6)
    v_mfma_f32_32x32x16_bf16 v[64:79], v[184:187], v[240:243], v[64:79]
    ds_read_b64_tr_b16 v[172:173], v8 offset:52224
    ds_read_b64_tr_b16 v[174:175], v8 offset:52736
    v_mfma_f32_32x32x16_bf16 v[80:95], v[188:191], v[240:243], v[80:95]
    ds_read_b64_tr_b16 v[176:177], v8 offset:53248
    ds_read_b64_tr_b16 v[178:179], v8 offset:53760
    v_mfma_f32_32x32x16_bf16 v[96:111], v[192:195], v[240:243], v[96:111]
    ds_read_b64_tr_b16 v[180:181], v8 offset:54272
    ds_read_b64_tr_b16 v[182:183], v8 offset:54784
    s_waitcnt vmcnt(8)
    s_waitcnt vmcnt(7) lgkmcnt(6)
    v_mfma_f32_32x32x16_bf16 v[64:79], v[160:163], v[196:199], v[64:79]
    ds_read_b64_tr_b16 v[184:185], v8 offset:55296
    ds_read_b64_tr_b16 v[186:187], v8 offset:55808
    v_add_f32 v56, v56, v58
    v_mfma_f32_32x32x16_bf16 v[80:95], v[164:167], v[196:199], v[80:95]
    ds_read_b64_tr_b16 v[188:189], v8 offset:56320
    ds_read_b64_tr_b16 v[190:191], v8 offset:56832
    v_add_f32 v57, v57, v59
    v_mfma_f32_32x32x16_bf16 v[96:111], v[168:171], v[196:199], v[96:111]
    ds_read_b64_tr_b16 v[192:193], v8 offset:57344
    ds_read_b64_tr_b16 v[194:195], v8 offset:57856
    v_add_f32 v60, v60, v62
    s_waitcnt vmcnt(6) lgkmcnt(6)
    v_mfma_f32_32x32x16_bf16 v[64:79], v[172:175], v[200:203], v[64:79]
    ds_read_b64_tr_b16 v[160:161], v8 offset:58368
    ds_read_b64_tr_b16 v[162:163], v8 offset:58880
    v_add_f32 v61, v61, v63
    v_mfma_f32_32x32x16_bf16 v[80:95], v[176:179], v[200:203], v[80:95]
    ds_read_b64_tr_b16 v[164:165], v8 offset:59392
    ds_read_b64_tr_b16 v[166:167], v8 offset:59904
    v_add_f32 v56, v56, v60
    v_mfma_f32_32x32x16_bf16 v[96:111], v[180:183], v[200:203], v[96:111]
    ds_read_b64_tr_b16 v[168:169], v8 offset:60416
    ds_read_b64_tr_b16 v[170:171], v8 offset:60928
    v_add_f32 v57, v57, v61
    s_waitcnt vmcnt(5) lgkmcnt(6)
    v_mfma_f32_32x32x16_bf16 v[64:79], v[184:187], v[204:207], v[64:79]
    ds_read_b64_tr_b16 v[172:173], v8 offset:61440
    ds_read_b64_tr_b16 v[174:175], v8 offset:61952
    v_mov_b32 v58, v56
    v_mfma_f32_32x32x16_bf16 v[80:95], v[188:191], v[204:207], v[80:95]
    ds_read_b64_tr_b16 v[176:177], v8 offset:62464
    ds_read_b64_tr_b16 v[178:179], v8 offset:62976
    v_mov_b32 v59, v57
    v_mfma_f32_32x32x16_bf16 v[96:111], v[192:195], v[204:207], v[96:111]
    ds_read_b64_tr_b16 v[180:181], v8 offset:63488
    ds_read_b64_tr_b16 v[182:183], v8 offset:64000
    v_permlane32_swap_b32 v56, v58
    s_waitcnt vmcnt(4) lgkmcnt(6)
    v_mfma_f32_32x32x16_bf16 v[64:79], v[160:163], v[208:211], v[64:79]
    ds_read_b64_tr_b16 v[184:185], v9 offset:24576
    ds_read_b64_tr_b16 v[186:187], v9 offset:25088
    v_permlane32_swap_b32 v57, v59
    v_mfma_f32_32x32x16_bf16 v[80:95], v[164:167], v[208:211], v[80:95]
    ds_read_b64_tr_b16 v[188:189], v9 offset:25600
    ds_read_b64_tr_b16 v[190:191], v9 offset:26112
    v_add_f32 v56, v56, v58
    v_mfma_f32_32x32x16_bf16 v[96:111], v[168:171], v[208:211], v[96:111]
    ds_read_b64_tr_b16 v[192:193], v9 offset:26624
    ds_read_b64_tr_b16 v[194:195], v9 offset:27136
    v_add_f32 v57, v57, v59
    s_waitcnt vmcnt(3) lgkmcnt(6)
    v_mfma_f32_32x32x16_bf16 v[64:79], v[172:175], v[212:215], v[64:79]
    ds_read_b64_tr_b16 v[160:161], v9 offset:27648
    ds_read_b64_tr_b16 v[162:163], v9 offset:28160
    v_mul_f32 v46, 0xbb000000, v56
    v_mfma_f32_32x32x16_bf16 v[80:95], v[176:179], v[212:215], v[80:95]
    ds_read_b64_tr_b16 v[164:165], v9 offset:28672
    ds_read_b64_tr_b16 v[166:167], v9 offset:29184
    v_mul_f32 v57, 0x3b000000, v57
    v_mfma_f32_32x32x16_bf16 v[96:111], v[180:183], v[212:215], v[96:111]
    ds_read_b64_tr_b16 v[168:169], v9 offset:29696
    ds_read_b64_tr_b16 v[170:171], v9 offset:30208
    v_fma_f32 v57, -v46, v46, v57
    s_waitcnt vmcnt(2) lgkmcnt(6)
    v_mfma_f32_32x32x16_bf16 v[64:79], v[184:187], v[216:219], v[64:79]
    ds_read_b64_tr_b16 v[172:173], v9 offset:30720
    ds_read_b64_tr_b16 v[174:175], v9 offset:31232
    v_max_f32 v57, 0, v57
    v_mfma_f32_32x32x16_bf16 v[80:95], v[188:191], v[216:219], v[80:95]
    ds_read_b64_tr_b16 v[176:177], v9 offset:31744
    ds_read_b64_tr_b16 v[178:179], v9 offset:32256
    v_add_f32 v57, 0x3727c5ac, v57
    v_mfma_f32_32x32x16_bf16 v[96:111], v[192:195], v[216:219], v[96:111]
    ds_read_b64_tr_b16 v[180:181], v8 offset:64512
    ds_read_b64_tr_b16 v[182:183], v8 offset:65024
    v_rsq_f32 v12, v57
    s_waitcnt vmcnt(1) lgkmcnt(6)
    v_mfma_f32_32x32x16_bf16 v[64:79], v[160:163], v[220:223], v[64:79]
    v_mfma_f32_32x32x16_bf16 v[80:95], v[164:167], v[220:223], v[80:95]
    v_mfma_f32_32x32x16_bf16 v[96:111], v[168:171], v[220:223], v[96:111]
    s_waitcnt vmcnt(0) lgkmcnt(0)
    v_mfma_f32_32x32x16_bf16 v[64:79], v[172:175], v[224:227], v[64:79]
    v_mfma_f32_32x32x16_bf16 v[80:95], v[176:179], v[224:227], v[80:95]
    v_mfma_f32_32x32x16_bf16 v[96:111], v[180:183], v[224:227], v[96:111]
    s_barrier
    s_nop 8
    v_pk_fma_f32 v[40:41], v[112:113], v[32:33], v[64:65] op_sel_hi:[1,0,1]
    v_pk_fma_f32 v[42:43], v[114:115], v[32:33], v[66:67] op_sel_hi:[1,0,1]
    v_pk_fma_f32 v[44:45], v[116:117], v[32:33], v[68:69] op_sel_hi:[1,0,1]
    v_pk_fma_f32 v[46:47], v[118:119], v[32:33], v[70:71] op_sel_hi:[1,0,1]
    v_pk_mul_f32 v[48:49], v[40:41], v[40:41]
    v_pk_mul_f32 v[50:51], v[42:43], v[42:43]
    v_pk_mul_f32 v[52:53], v[44:45], v[44:45]
    v_pk_mul_f32 v[54:55], v[46:47], v[46:47]
    v_pk_fma_f32 v[48:49], v[48:49], v[2:3], v[38:39] op_sel_hi:[1,0,0]
    v_pk_fma_f32 v[50:51], v[50:51], v[2:3], v[38:39] op_sel_hi:[1,0,0]
    v_pk_fma_f32 v[52:53], v[52:53], v[2:3], v[38:39] op_sel_hi:[1,0,0]
    v_pk_fma_f32 v[54:55], v[54:55], v[2:3], v[38:39] op_sel_hi:[1,0,0]
    v_pk_mul_f32 v[48:49], v[48:49], v[40:41]
    v_pk_mul_f32 v[50:51], v[50:51], v[42:43]
    v_pk_mul_f32 v[52:53], v[52:53], v[44:45]
    v_pk_mul_f32 v[54:55], v[54:55], v[46:47]
    v_exp_f32 v48, v48
    v_exp_f32 v49, v49
    v_exp_f32 v50, v50
    v_exp_f32 v51, v51
    v_exp_f32 v52, v52
    v_exp_f32 v53, v53
    v_exp_f32 v54, v54
    v_exp_f32 v55, v55
    v_pk_add_f32 v[48:49], v[48:49], 1.0 op_sel_hi:[1,0]
    v_pk_add_f32 v[50:51], v[50:51], 1.0 op_sel_hi:[1,0]
    v_pk_add_f32 v[52:53], v[52:53], 1.0 op_sel_hi:[1,0]
    v_pk_add_f32 v[54:55], v[54:55], 1.0 op_sel_hi:[1,0]
    v_rcp_f32 v48, v48
    v_rcp_f32 v49, v49
    v_rcp_f32 v50, v50
    v_rcp_f32 v51, v51
    v_rcp_f32 v52, v52
    v_rcp_f32 v53, v53
    v_rcp_f32 v54, v54
    v_rcp_f32 v55, v55
    v_pk_mul_f32 v[40:41], v[40:41], v[48:49]
    v_pk_mul_f32 v[42:43], v[42:43], v[50:51]
    v_pk_mul_f32 v[44:45], v[44:45], v[52:53]
    v_pk_mul_f32 v[46:47], v[46:47], v[54:55]
    v_cvt_pk_bf16_f32 v56, v40, v41
    v_cvt_pk_bf16_f32 v57, v42, v43
    v_cvt_pk_bf16_f32 v58, v44, v45
    v_cvt_pk_bf16_f32 v59, v46, v47
    v_pk_fma_f32 v[40:41], v[120:121], v[32:33], v[72:73] op_sel_hi:[1,0,1]
    v_pk_fma_f32 v[42:43], v[122:123], v[32:33], v[74:75] op_sel_hi:[1,0,1]
    v_pk_fma_f32 v[44:45], v[124:125], v[32:33], v[76:77] op_sel_hi:[1,0,1]
    v_pk_fma_f32 v[46:47], v[126:127], v[32:33], v[78:79] op_sel_hi:[1,0,1]
    v_pk_mul_f32 v[48:49], v[40:41], v[40:41]
    v_pk_mul_f32 v[50:51], v[42:43], v[42:43]
    v_pk_mul_f32 v[52:53], v[44:45], v[44:45]
    v_pk_mul_f32 v[54:55], v[46:47], v[46:47]
    v_pk_fma_f32 v[48:49], v[48:49], v[2:3], v[38:39] op_sel_hi:[1,0,0]
    v_pk_fma_f32 v[50:51], v[50:51], v[2:3], v[38:39] op_sel_hi:[1,0,0]
    v_pk_fma_f32 v[52:53], v[52:53], v[2:3], v[38:39] op_sel_hi:[1,0,0]
    v_pk_fma_f32 v[54:55], v[54:55], v[2:3], v[38:39] op_sel_hi:[1,0,0]
    v_pk_mul_f32 v[48:49], v[48:49], v[40:41]
    v_pk_mul_f32 v[50:51], v[50:51], v[42:43]
    v_pk_mul_f32 v[52:53], v[52:53], v[44:45]
    v_pk_mul_f32 v[54:55], v[54:55], v[46:47]
    v_exp_f32 v48, v48
    v_exp_f32 v49, v49
    v_exp_f32 v50, v50
    v_exp_f32 v51, v51
    v_exp_f32 v52, v52
    v_exp_f32 v53, v53
    v_exp_f32 v54, v54
    v_exp_f32 v55, v55
    v_pk_add_f32 v[48:49], v[48:49], 1.0 op_sel_hi:[1,0]
    v_pk_add_f32 v[50:51], v[50:51], 1.0 op_sel_hi:[1,0]
    v_pk_add_f32 v[52:53], v[52:53], 1.0 op_sel_hi:[1,0]
    v_pk_add_f32 v[54:55], v[54:55], 1.0 op_sel_hi:[1,0]
    v_rcp_f32 v48, v48
    v_rcp_f32 v49, v49
    v_rcp_f32 v50, v50
    v_rcp_f32 v51, v51
    v_rcp_f32 v52, v52
    v_rcp_f32 v53, v53
    v_rcp_f32 v54, v54
    v_rcp_f32 v55, v55
    v_pk_mul_f32 v[40:41], v[40:41], v[48:49]
    v_pk_mul_f32 v[42:43], v[42:43], v[50:51]
    v_pk_mul_f32 v[44:45], v[44:45], v[52:53]
    v_pk_mul_f32 v[46:47], v[46:47], v[54:55]
    v_cvt_pk_bf16_f32 v60, v40, v41
    v_cvt_pk_bf16_f32 v61, v42, v43
    v_cvt_pk_bf16_f32 v62, v44, v45
    v_cvt_pk_bf16_f32 v63, v46, v47
    buffer_store_dwordx4 v[56:59], v15, s[28:31], 0 offen offset:0 sc1
    buffer_store_dwordx4 v[60:63], v15, s[28:31], 0 offen offset:1024 sc1
    v_pk_fma_f32 v[40:41], v[128:129], v[32:33], v[80:81] op_sel_hi:[1,0,1]
    v_pk_fma_f32 v[42:43], v[130:131], v[32:33], v[82:83] op_sel_hi:[1,0,1]
    v_pk_fma_f32 v[44:45], v[132:133], v[32:33], v[84:85] op_sel_hi:[1,0,1]
    v_pk_fma_f32 v[46:47], v[134:135], v[32:33], v[86:87] op_sel_hi:[1,0,1]
    v_pk_mul_f32 v[48:49], v[40:41], v[40:41]
    v_pk_mul_f32 v[50:51], v[42:43], v[42:43]
    v_pk_mul_f32 v[52:53], v[44:45], v[44:45]
    v_pk_mul_f32 v[54:55], v[46:47], v[46:47]
    v_pk_fma_f32 v[48:49], v[48:49], v[2:3], v[38:39] op_sel_hi:[1,0,0]
    v_pk_fma_f32 v[50:51], v[50:51], v[2:3], v[38:39] op_sel_hi:[1,0,0]
    v_pk_fma_f32 v[52:53], v[52:53], v[2:3], v[38:39] op_sel_hi:[1,0,0]
    v_pk_fma_f32 v[54:55], v[54:55], v[2:3], v[38:39] op_sel_hi:[1,0,0]
    v_pk_mul_f32 v[48:49], v[48:49], v[40:41]
    v_pk_mul_f32 v[50:51], v[50:51], v[42:43]
    v_pk_mul_f32 v[52:53], v[52:53], v[44:45]
    v_pk_mul_f32 v[54:55], v[54:55], v[46:47]
    v_exp_f32 v48, v48
    v_exp_f32 v49, v49
    v_exp_f32 v50, v50
    v_exp_f32 v51, v51
    v_exp_f32 v52, v52
    v_exp_f32 v53, v53
    v_exp_f32 v54, v54
    v_exp_f32 v55, v55
    v_pk_add_f32 v[48:49], v[48:49], 1.0 op_sel_hi:[1,0]
    v_pk_add_f32 v[50:51], v[50:51], 1.0 op_sel_hi:[1,0]
    v_pk_add_f32 v[52:53], v[52:53], 1.0 op_sel_hi:[1,0]
    v_pk_add_f32 v[54:55], v[54:55], 1.0 op_sel_hi:[1,0]
    v_rcp_f32 v48, v48
    v_rcp_f32 v49, v49
    v_rcp_f32 v50, v50
    v_rcp_f32 v51, v51
    v_rcp_f32 v52, v52
    v_rcp_f32 v53, v53
    v_rcp_f32 v54, v54
    v_rcp_f32 v55, v55
    v_pk_mul_f32 v[40:41], v[40:41], v[48:49]
    v_pk_mul_f32 v[42:43], v[42:43], v[50:51]
    v_pk_mul_f32 v[44:45], v[44:45], v[52:53]
    v_pk_mul_f32 v[46:47], v[46:47], v[54:55]
    v_cvt_pk_bf16_f32 v56, v40, v41
    v_cvt_pk_bf16_f32 v57, v42, v43
    v_cvt_pk_bf16_f32 v58, v44, v45
    v_cvt_pk_bf16_f32 v59, v46, v47
    v_pk_fma_f32 v[40:41], v[136:137], v[32:33], v[88:89] op_sel_hi:[1,0,1]
    v_pk_fma_f32 v[42:43], v[138:139], v[32:33], v[90:91] op_sel_hi:[1,0,1]
    v_pk_fma_f32 v[44:45], v[140:141], v[32:33], v[92:93] op_sel_hi:[1,0,1]
    v_pk_fma_f32 v[46:47], v[142:143], v[32:33], v[94:95] op_sel_hi:[1,0,1]
    v_pk_mul_f32 v[48:49], v[40:41], v[40:41]
    v_pk_mul_f32 v[50:51], v[42:43], v[42:43]
    v_pk_mul_f32 v[52:53], v[44:45], v[44:45]
    v_pk_mul_f32 v[54:55], v[46:47], v[46:47]
    v_pk_fma_f32 v[48:49], v[48:49], v[2:3], v[38:39] op_sel_hi:[1,0,0]
    v_pk_fma_f32 v[50:51], v[50:51], v[2:3], v[38:39] op_sel_hi:[1,0,0]
    v_pk_fma_f32 v[52:53], v[52:53], v[2:3], v[38:39] op_sel_hi:[1,0,0]
    v_pk_fma_f32 v[54:55], v[54:55], v[2:3], v[38:39] op_sel_hi:[1,0,0]
    v_pk_mul_f32 v[48:49], v[48:49], v[40:41]
    v_pk_mul_f32 v[50:51], v[50:51], v[42:43]
    v_pk_mul_f32 v[52:53], v[52:53], v[44:45]
    v_pk_mul_f32 v[54:55], v[54:55], v[46:47]
    v_exp_f32 v48, v48
    v_exp_f32 v49, v49
    v_exp_f32 v50, v50
    v_exp_f32 v51, v51
    v_exp_f32 v52, v52
    v_exp_f32 v53, v53
    v_exp_f32 v54, v54
    v_exp_f32 v55, v55
    v_pk_add_f32 v[48:49], v[48:49], 1.0 op_sel_hi:[1,0]
    v_pk_add_f32 v[50:51], v[50:51], 1.0 op_sel_hi:[1,0]
    v_pk_add_f32 v[52:53], v[52:53], 1.0 op_sel_hi:[1,0]
    v_pk_add_f32 v[54:55], v[54:55], 1.0 op_sel_hi:[1,0]
    v_rcp_f32 v48, v48
    v_rcp_f32 v49, v49
    v_rcp_f32 v50, v50
    v_rcp_f32 v51, v51
    v_rcp_f32 v52, v52
    v_rcp_f32 v53, v53
    v_rcp_f32 v54, v54
    v_rcp_f32 v55, v55
    v_pk_mul_f32 v[40:41], v[40:41], v[48:49]
    v_pk_mul_f32 v[42:43], v[42:43], v[50:51]
    v_pk_mul_f32 v[44:45], v[44:45], v[52:53]
    v_pk_mul_f32 v[46:47], v[46:47], v[54:55]
    v_cvt_pk_bf16_f32 v60, v40, v41
    v_cvt_pk_bf16_f32 v61, v42, v43
    v_cvt_pk_bf16_f32 v62, v44, v45
    v_cvt_pk_bf16_f32 v63, v46, v47
    buffer_store_dwordx4 v[56:59], v15, s[28:31], 0 offen offset:2048 sc1
    buffer_store_dwordx4 v[60:63], v15, s[28:31], 0 offen offset:3072 sc1
    v_pk_fma_f32 v[40:41], v[144:145], v[32:33], v[96:97] op_sel_hi:[1,0,1]
    v_pk_fma_f32 v[42:43], v[146:147], v[32:33], v[98:99] op_sel_hi:[1,0,1]
    v_pk_fma_f32 v[44:45], v[148:149], v[32:33], v[100:101] op_sel_hi:[1,0,1]
    v_pk_fma_f32 v[46:47], v[150:151], v[32:33], v[102:103] op_sel_hi:[1,0,1]
    v_pk_mul_f32 v[48:49], v[40:41], v[40:41]
    v_pk_mul_f32 v[50:51], v[42:43], v[42:43]
    v_pk_mul_f32 v[52:53], v[44:45], v[44:45]
    v_pk_mul_f32 v[54:55], v[46:47], v[46:47]
    v_pk_fma_f32 v[48:49], v[48:49], v[2:3], v[38:39] op_sel_hi:[1,0,0]
    v_pk_fma_f32 v[50:51], v[50:51], v[2:3], v[38:39] op_sel_hi:[1,0,0]
    v_pk_fma_f32 v[52:53], v[52:53], v[2:3], v[38:39] op_sel_hi:[1,0,0]
    v_pk_fma_f32 v[54:55], v[54:55], v[2:3], v[38:39] op_sel_hi:[1,0,0]
    v_pk_mul_f32 v[48:49], v[48:49], v[40:41]
    v_pk_mul_f32 v[50:51], v[50:51], v[42:43]
    v_pk_mul_f32 v[52:53], v[52:53], v[44:45]
    v_pk_mul_f32 v[54:55], v[54:55], v[46:47]
    v_exp_f32 v48, v48
    v_exp_f32 v49, v49
    v_exp_f32 v50, v50
    v_exp_f32 v51, v51
    v_exp_f32 v52, v52
    v_exp_f32 v53, v53
    v_exp_f32 v54, v54
    v_exp_f32 v55, v55
    v_pk_add_f32 v[48:49], v[48:49], 1.0 op_sel_hi:[1,0]
    v_pk_add_f32 v[50:51], v[50:51], 1.0 op_sel_hi:[1,0]
    v_pk_add_f32 v[52:53], v[52:53], 1.0 op_sel_hi:[1,0]
    v_pk_add_f32 v[54:55], v[54:55], 1.0 op_sel_hi:[1,0]
    v_rcp_f32 v48, v48
    v_rcp_f32 v49, v49
    v_rcp_f32 v50, v50
    v_rcp_f32 v51, v51
    v_rcp_f32 v52, v52
    v_rcp_f32 v53, v53
    v_rcp_f32 v54, v54
    v_rcp_f32 v55, v55
    v_pk_mul_f32 v[40:41], v[40:41], v[48:49]
    v_pk_mul_f32 v[42:43], v[42:43], v[50:51]
    v_pk_mul_f32 v[44:45], v[44:45], v[52:53]
    v_pk_mul_f32 v[46:47], v[46:47], v[54:55]
    v_cvt_pk_bf16_f32 v56, v40, v41
    v_cvt_pk_bf16_f32 v57, v42, v43
    v_cvt_pk_bf16_f32 v58, v44, v45
    v_cvt_pk_bf16_f32 v59, v46, v47
    v_pk_fma_f32 v[40:41], v[152:153], v[32:33], v[104:105] op_sel_hi:[1,0,1]
    v_pk_fma_f32 v[42:43], v[154:155], v[32:33], v[106:107] op_sel_hi:[1,0,1]
    v_pk_fma_f32 v[44:45], v[156:157], v[32:33], v[108:109] op_sel_hi:[1,0,1]
    v_pk_fma_f32 v[46:47], v[158:159], v[32:33], v[110:111] op_sel_hi:[1,0,1]
    v_pk_mul_f32 v[48:49], v[40:41], v[40:41]
    v_pk_mul_f32 v[50:51], v[42:43], v[42:43]
    v_pk_mul_f32 v[52:53], v[44:45], v[44:45]
    v_pk_mul_f32 v[54:55], v[46:47], v[46:47]
    v_pk_fma_f32 v[48:49], v[48:49], v[2:3], v[38:39] op_sel_hi:[1,0,0]
    v_pk_fma_f32 v[50:51], v[50:51], v[2:3], v[38:39] op_sel_hi:[1,0,0]
    v_pk_fma_f32 v[52:53], v[52:53], v[2:3], v[38:39] op_sel_hi:[1,0,0]
    v_pk_fma_f32 v[54:55], v[54:55], v[2:3], v[38:39] op_sel_hi:[1,0,0]
    v_pk_mul_f32 v[48:49], v[48:49], v[40:41]
    v_pk_mul_f32 v[50:51], v[50:51], v[42:43]
    v_pk_mul_f32 v[52:53], v[52:53], v[44:45]
    v_pk_mul_f32 v[54:55], v[54:55], v[46:47]
    v_exp_f32 v48, v48
    v_exp_f32 v49, v49
    v_exp_f32 v50, v50
    v_exp_f32 v51, v51
    v_exp_f32 v52, v52
    v_exp_f32 v53, v53
    v_exp_f32 v54, v54
    v_exp_f32 v55, v55
    v_pk_add_f32 v[48:49], v[48:49], 1.0 op_sel_hi:[1,0]
    v_pk_add_f32 v[50:51], v[50:51], 1.0 op_sel_hi:[1,0]
    v_pk_add_f32 v[52:53], v[52:53], 1.0 op_sel_hi:[1,0]
    v_pk_add_f32 v[54:55], v[54:55], 1.0 op_sel_hi:[1,0]
    v_rcp_f32 v48, v48
    v_rcp_f32 v49, v49
    v_rcp_f32 v50, v50
    v_rcp_f32 v51, v51
    v_rcp_f32 v52, v52
    v_rcp_f32 v53, v53
    v_rcp_f32 v54, v54
    v_rcp_f32 v55, v55
    v_pk_mul_f32 v[40:41], v[40:41], v[48:49]
    v_pk_mul_f32 v[42:43], v[42:43], v[50:51]
    v_pk_mul_f32 v[44:45], v[44:45], v[52:53]
    v_pk_mul_f32 v[46:47], v[46:47], v[54:55]
    v_cvt_pk_bf16_f32 v60, v40, v41
    v_cvt_pk_bf16_f32 v61, v42, v43
    v_cvt_pk_bf16_f32 v62, v44, v45
    v_cvt_pk_bf16_f32 v63, v46, v47
    s_cmp_ge_u32 s53, 11
    s_cbranch_scc1 Lnou217
    buffer_store_dwordx4 v[56:59], v15, s[28:31], s42 offen offset:0 sc1
    buffer_store_dwordx4 v[60:63], v15, s[28:31], s42 offen offset:1024 sc1
Lnou217:
    v_mov_b32 v30, v5
    s_waitcnt vmcnt(0)
    v_mov_b32 v28, s50
    v_mov_b32 v29, s51
    s_mov_b64 exec, 1
    s_cmp_eq_u32 s57, 0
    s_cbranch_scc1 Lslow18
    buffer_store_dwordx2 v[28:29], v30, s[28:31], 0 offen
    s_branch Ldone19
Lslow18:
    buffer_store_dwordx2 v[28:29], v30, s[28:31], 0 offen sc1
Ldone19:
    s_mov_b64 exec, -1
    buffer_load_dwordx2 v[28:29], v244, s[28:31], 0 offen sc1
    s_barrier
    s_mov_b32 s80, 0
Lpoll20:
    s_waitcnt vmcnt(0)
    v_cmp_ne_u64 vcc, s[50:51], v[28:29]
    s_cbranch_vccz Lpollok21
    s_add_u32 s80, s80, 1
    s_cmp_gt_u32 s80, 0x40000
    s_cbranch_scc1 Lpollok21
    s_cmp_lg_u32 s57, 0
    s_cbranch_scc1 Lnosleep22
    s_sleep 8
Lnosleep22:
    buffer_load_dwordx2 v[28:29], v244, s[28:31], 0 offen sc1
    s_branch Lpoll20
Lpollok21:
    s_mov_b32 s78, 0
    buffer_load_dwordx4 v[112:115], v246, s[28:31], s78 offen offset:0 sc1
    buffer_load_dwordx4 v[116:119], v246, s[28:31], s78 offen offset:1024 sc1
    buffer_load_dwordx4 v[120:123], v246, s[28:31], s78 offen offset:2048 sc1
    buffer_load_dwordx4 v[124:127], v246, s[28:31], s78 offen offset:3072 sc1
    s_mov_b32 s78, 4096
    buffer_load_dwordx4 v[128:131], v246, s[28:31], s78 offen offset:0 sc1
    buffer_load_dwordx4 v[132:135], v246, s[28:31], s78 offen offset:1024 sc1
    buffer_load_dwordx4 v[136:139], v246, s[28:31], s78 offen offset:2048 sc1
    buffer_load_dwordx4 v[140:143], v246, s[28:31], s78 offen offset:3072 sc1
    s_mov_b32 s78, 8192
    buffer_load_dwordx4 v[144:147], v246, s[28:31], s78 offen offset:0 sc1
    buffer_load_dwordx4 v[148:151], v246, s[28:31], s78 offen offset:1024 sc1
    buffer_load_dwordx4 v[152:155], v246, s[28:31], s78 offen offset:2048 sc1
    buffer_load_dwordx4 v[156:159], v246, s[28:31], s78 offen offset:3072 sc1
    ds_read_b64_tr_b16 v[176:177], v248 offset:0
    ds_read_b64_tr_b16 v[178:179], v248 offset:512
    ds_read_b64_tr_b16 v[180:181], v249 offset:0
    ds_read_b64_tr_b16 v[182:183], v249 offset:512
    ds_read_b64_tr_b16 v[184:185], v248 offset:2048
    ds_read_b64_tr_b16 v[186:187], v248 offset:2560
    ds_read_b64_tr_b16 v[188:189], v249 offset:2048
    ds_read_b64_tr_b16 v[190:191], v249 offset:2560
    s_waitcnt vmcnt(11) lgkmcnt(4)
    v_mfma_f32_32x32x16_bf16 v[64:79], v[176:179], v[112:115], 0
    ds_read_b64_tr_b16 v[192:193], v248 offset:4096
    ds_read_b64_tr_b16 v[194:195], v248 offset:4608
    v_mfma_f32_32x32x16_bf16 v[80:95], v[180:183], v[112:115], 0
    ds_read_b64_tr_b16 v[196:197], v249 offset:4096
    ds_read_b64_tr_b16 v[198:199], v249 offset:4608
    s_mov_b32 s78, 12288
    buffer_load_dwordx4 v[160:163], v246, s[28:31], s78 offen offset:0 sc1
    s_waitcnt vmcnt(11) lgkmcnt(4)
    v_mfma_f32_32x32x16_bf16 v[64:79], v[184:187], v[116:119], v[64:79]
    ds_read_b64_tr_b16 v[176:177], v248 offset:6144
    ds_read_b64_tr_b16 v[178:179], v248 offset:6656
    v_mfma_f32_32x32x16_bf16 v[80:95], v[188:191], v[116:119], v[80:95]
    ds_read_b64_tr_b16 v[180:181], v249 offset:6144
    ds_read_b64_tr_b16 v[182:183], v249 offset:6656
    buffer_load_dwordx4 v[164:167], v246, s[28:31], s78 offen offset:1024 sc1
    s_waitcnt vmcnt(11) lgkmcnt(4)
    v_mfma_f32_32x32x16_bf16 v[64:79], v[192:195], v[120:123], v[64:79]
    ds_read_b64_tr_b16 v[184:185], v248 offset:8192
    ds_read_b64_tr_b16 v[186:187], v248 offset:8704
    v_mfma_f32_32x32x16_bf16 v[80:95], v[196:199], v[120:123], v[80:95]
    ds_read_b64_tr_b16 v[188:189], v249 offset:8192
    ds_read_b64_tr_b16 v[190:191], v249 offset:8704
    buffer_load_dwordx4 v[168:171], v246, s[28:31], s78 offen offset:2048 sc1
    s_waitcnt vmcnt(11) lgkmcnt(4)
    v_mfma_f32_32x32x16_bf16 v[64:79], v[176:179], v[124:127], v[64:79]
    ds_read_b64_tr_b16 v[192:193], v248 offset:10240
    ds_read_b64_tr_b16 v[194:195], v248 offset:10752
    v_mfma_f32_32x32x16_bf16 v[80:95], v[180:183], v[124:127], v[80:95]
    ds_read_b64_tr_b16 v[196:197], v249 offset:10240
    ds_read_b64_tr_b16 v[198:199], v249 offset:10752
    buffer_load_dwordx4 v[172:175], v246, s[28:31], s78 offen offset:3072 sc1
    s_barrier
    s_waitcnt vmcnt(11) lgkmcnt(4)
    v_mfma_f32_32x32x16_bf16 v[64:79], v[184:187], v[128:131], v[64:79]
    ds_read_b64_tr_b16 v[176:177], v248 offset:12288
    ds_read_b64_tr_b16 v[178:179], v248 offset:12800
    v_mfma_f32_32x32x16_bf16 v[80:95], v[188:191], v[128:131], v[80:95]
    ds_read_b64_tr_b16 v[180:181], v249 offset:12288
    ds_read_b64_tr_b16 v[182:183], v249 offset:12800
    s_mov_b32 s78, 16384
    buffer_load_dwordx4 v[112:115], v246, s[28:31], s78 offen offset:0 sc1
    s_waitcnt vmcnt(11) lgkmcnt(4)
    v_mfma_f32_32x32x16_bf16 v[64:79], v[192:195], v[132:135], v[64:79]
    ds_read_b64_tr_b16 v[184:185], v248 offset:14336
    ds_read_b64_tr_b16 v[186:187], v248 offset:14848
    v_mfma_f32_32x32x16_bf16 v[80:95], v[196:199], v[132:135], v[80:95]
    ds_read_b64_tr_b16 v[188:189], v249 offset:14336
    ds_read_b64_tr_b16 v[190:191], v249 offset:14848
    buffer_load_dwordx4 v[116:119], v246, s[28:31], s78 offen offset:1024 sc1
    s_waitcnt vmcnt(11) lgkmcnt(4)
    v_mfma_f32_32x32x16_bf16 v[64:79], v[176:179], v[136:139], v[64:79]
    ds_read_b64_tr_b16 v[192:193], v248 offset:16384
    ds_read_b64_tr_b16 v[194:195], v248 offset:16896
    v_mfma_f32_32x32x16_bf16 v[80:95], v[180:183], v[136:139], v[80:95]
    ds_read_b64_tr_b16 v[196:197], v249 offset:16384
    ds_read_b64_tr_b16 v[198:199], v249 offset:16896
    buffer_load_dwordx4 v[120:123], v246, s[28:31], s78 offen offset:2048 sc1
    s_waitcnt vmcnt(11) lgkmcnt(4)
    v_mfma_f32_32x32x16_bf16 v[64:79], v[184:187], v[140:143], v[64:79]
    ds_read_b64_tr_b16 v[176:177], v248 offset:18432
    ds_read_b64_tr_b16 v[178:179], v248 offset:18944
    v_mfma_f32_32x32x16_bf16 v[80:95], v[188:191], v[140:143], v[80:95]
    ds_read_b64_tr_b16 v[180:181], v249 offset:18432
    ds_read_b64_tr_b16 v[182:183], v249 offset:18944
    buffer_load_dwordx4 v[124:127], v246, s[28:31], s78 offen offset:3072 sc1
    s_waitcnt vmcnt(11) lgkmcnt(4)
    v_mfma_f32_32x32x16_bf16 v[64:79], v[192:195], v[144:147], v[64:79]
    ds_read_b64_tr_b16 v[184:185], v248 offset:20480
    ds_read_b64_tr_b16 v[186:187], v248 offset:20992
    v_mfma_f32_32x32x16_bf16 v[80:95], v[196:199], v[144:147], v[80:95]
    ds_read_b64_tr_b16 v[188:189], v249 offset:20480
    ds_read_b64_tr_b16 v[190:191], v249 offset:20992
    s_mov_b32 s78, 20480
    buffer_load_dwordx4 v[128:131], v246, s[28:31], s78 offen offset:0 sc1
    s_waitcnt vmcnt(11) lgkmcnt(4)
    v_mfma_f32_32x32x16_bf16 v[64:79], v[176:179], v[148:151], v[64:79]
    ds_read_b64_tr_b16 v[192:193], v248 offset:22528
    ds_read_b64_tr_b16 v[194:195], v248 offset:23040
    v_mfma_f32_32x32x16_bf16 v[80:95], v[180:183], v[148:151], v[80:95]
    ds_read_b64_tr_b16 v[196:197], v249 offset:22528
    ds_read_b64_tr_b16 v[198:199], v249 offset:23040
    buffer_load_dwordx4 v[132:135], v246, s[28:31], s78 offen offset:1024 sc1
    s_waitcnt vmcnt(11) lgkmcnt(4)
    v_mfma_f32_32x32x16_bf16 v[64:79], v[184:187], v[152:155], v[64:79]
    ds_read_b64_tr_b16 v[176:177], v248 offset:24576
    ds_read_b64_tr_b16 v[178:179], v248 offset:25088
    v_mfma_f32_32x32x16_bf16 v[80:95], v[188:191], v[152:155], v[80:95]
    ds_read_b64_tr_b16 v[180:181], v249 offset:24576
    ds_read_b64_tr_b16 v[182:183], v249 offset:25088
    buffer_load_dwordx4 v[136:139], v246, s[28:31], s78 offen offset:2048 sc1
    s_waitcnt vmcnt(11) lgkmcnt(4)
    v_mfma_f32_32x32x16_bf16 v[64:79], v[192:195], v[156:159], v[64:79]
    ds_read_b64_tr_b16 v[184:185], v248 offset:26624
    ds_read_b64_tr_b16 v[186:187], v248 offset:27136
    v_mfma_f32_32x32x16_bf16 v[80:95], v[196:199], v[156:159], v[80:95]
    ds_read_b64_tr_b16 v[188:189], v249 offset:26624
    ds_read_b64_tr_b16 v[190:191], v249 offset:27136
    buffer_load_dwordx4 v[140:143], v246, s[28:31], s78 offen offset:3072 sc1
    s_waitcnt vmcnt(11) lgkmcnt(4)
    v_mfma_f32_32x32x16_bf16 v[64:79], v[176:179], v[160:163], v[64:79]
    ds_read_b64_tr_b16 v[192:193], v248 offset:28672
    ds_read_b64_tr_b16 v[194:195], v248 offset:29184
    v_mfma_f32_32x32x16_bf16 v[80:95], v[180:183], v[160:163], v[80:95]
    ds_read_b64_tr_b16 v[196:197], v249 offset:28672
    ds_read_b64_tr_b16 v[198:199], v249 offset:29184
    s_mov_b32 s78, 24576
    buffer_load_dwordx4 v[144:147], v246, s[28:31], s78 offen offset:0 sc1
    s_waitcnt vmcnt(11) lgkmcnt(4)
    v_mfma_f32_32x32x16_bf16 v[64:79], v[184:187], v[164:167], v[64:79]
    ds_read_b64_tr_b16 v[176:177], v248 offset:30720
    ds_read_b64_tr_b16 v[178:179], v248 offset:31232
    v_mfma_f32_32x32x16_bf16 v[80:95], v[188:191], v[164:167], v[80:95]
    ds_read_b64_tr_b16 v[180:181], v249 offset:30720
    ds_read_b64_tr_b16 v[182:183], v249 offset:31232
    buffer_load_dwordx4 v[148:151], v246, s[28:31], s78 offen offset:1024 sc1
    s_waitcnt vmcnt(11) lgkmcnt(4)
    v_mfma_f32_32x32x16_bf16 v[64:79], v[192:195], v[168:171], v[64:79]
    ds_read_b64_tr_b16 v[184:185], v250 offset:0
    ds_read_b64_tr_b16 v[186:187], v250 offset:512
    v_mfma_f32_32x32x16_bf16 v[80:95], v[196:199], v[168:171], v[80:95]
    ds_read_b64_tr_b16 v[188:189], v251 offset:0
    ds_read_b64_tr_b16 v[190:191], v251 offset:512
    buffer_load_dwordx4 v[152:155], v246, s[28:31], s78 offen offset:2048 sc1
    s_waitcnt vmcnt(11) lgkmcnt(4)
    v_mfma_f32_32x32x16_bf16 v[64:79], v[176:179], v[172:175], v[64:79]
    ds_read_b64_tr_b16 v[192:193], v250 offset:2048
    ds_read_b64_tr_b16 v[194:195], v250 offset:2560
    v_mfma_f32_32x32x16_bf16 v[80:95], v[180:183], v[172:175], v[80:95]
    ds_read_b64_tr_b16 v[196:197], v251 offset:2048
    ds_read_b64_tr_b16 v[198:199], v251 offset:2560
    buffer_load_dwordx4 v[156:159], v246, s[28:31], s78 offen offset:3072 sc1
    s_waitcnt vmcnt(11) lgkmcnt(4)
    v_mfma_f32_32x32x16_bf16 v[64:79], v[184:187], v[112:115], v[64:79]
    ds_read_b64_tr_b16 v[176:177], v250 offset:4096
    ds_read_b64_tr_b16 v[178:179], v250 offset:4608
    v_mfma_f32_32x32x16_bf16 v[80:95], v[188:191], v[112:115], v[80:95]
    ds_read_b64_tr_b16 v[180:181], v251 offset:4096
    ds_read_b64_tr_b16 v[182:183], v251 offset:4608
    s_mov_b32 s78, 28672
    buffer_load_dwordx4 v[160:163], v246, s[28:31], s78 offen offset:0 sc1
    s_waitcnt vmcnt(11) lgkmcnt(4)
    v_mfma_f32_32x32x16_bf16 v[64:79], v[192:195], v[116:119], v[64:79]
    ds_read_b64_tr_b16 v[184:185], v250 offset:6144
    ds_read_b64_tr_b16 v[186:187], v250 offset:6656
    v_mfma_f32_32x32x16_bf16 v[80:95], v[196:199], v[116:119], v[80:95]
    ds_read_b64_tr_b16 v[188:189], v251 offset:6144
    ds_read_b64_tr_b16 v[190:191], v251 offset:6656
    buffer_load_dwordx4 v[164:167], v246, s[28:31], s78 offen offset:1024 sc1
    s_waitcnt vmcnt(11) lgkmcnt(4)
    v_mfma_f32_32x32x16_bf16 v[64:79], v[176:179], v[120:123], v[64:79]
    ds_read_b64_tr_b16 v[192:193], v250 offset:8192
    ds_read_b64_tr_b16 v[194:195], v250 offset:8704
    v_mfma_f32_32x32x16_bf16 v[80:95], v[180:183], v[120:123], v[80:95]
    ds_read_b64_tr_b16 v[196:197], v251 offset:8192
    ds_read_b64_tr_b16 v[198:199], v251 offset:8704
    buffer_load_dwordx4 v[168:171], v246, s[28:31], s78 offen offset:2048 sc1
    s_waitcnt vmcnt(11) lgkmcnt(4)
    v_mfma_f32_32x32x16_bf16 v[64:79], v[184:187], v[124:127], v[64:79]
    ds_read_b64_tr_b16 v[176:177], v250 offset:10240
    ds_read_b64_tr_b16 v[178:179], v250 offset:10752
    v_mfma_f32_32x32x16_bf16 v[80:95], v[188:191], v[124:127], v[80:95]
    ds_read_b64_tr_b16 v[180:181], v251 offset:10240
    ds_read_b64_tr_b16 v[182:183], v251 offset:10752
    buffer_load_dwordx4 v[172:175], v246, s[28:31], s78 offen offset:3072 sc1
    s_waitcnt vmcnt(11) lgkmcnt(4)
    v_mfma_f32_32x32x16_bf16 v[64:79], v[192:195], v[128:131], v[64:79]
    ds_read_b64_tr_b16 v[184:185], v250 offset:12288
    ds_read_b64_tr_b16 v[186:187], v250 offset:12800
    v_mfma_f32_32x32x16_bf16 v[80:95], v[196:199], v[128:131], v[80:95]
    ds_read_b64_tr_b16 v[188:189], v251 offset:12288
    ds_read_b64_tr_b16 v[190:191], v251 offset:12800
    s_mov_b32 s78, 32768
    buffer_load_dwordx4 v[112:115], v246, s[28:31], s78 offen offset:0 sc1
    s_waitcnt vmcnt(11) lgkmcnt(4)
    v_mfma_f32_32x32x16_bf16 v[64:79], v[176:179], v[132:135], v[64:79]
    ds_read_b64_tr_b16 v[192:193], v250 offset:14336
    ds_read_b64_tr_b16 v[194:195], v250 offset:14848
    v_mfma_f32_32x32x16_bf16 v[80:95], v[180:183], v[132:135], v[80:95]
    ds_read_b64_tr_b16 v[196:197], v251 offset:14336
    ds_read_b64_tr_b16 v[198:199], v251 offset:14848
    buffer_load_dwordx4 v[116:119], v246, s[28:31], s78 offen offset:1024 sc1
    s_waitcnt vmcnt(11) lgkmcnt(4)
    v_mfma_f32_32x32x16_bf16 v[64:79], v[184:187], v[136:139], v[64:79]
    ds_read_b64_tr_b16 v[176:177], v250 offset:16384
    ds_read_b64_tr_b16 v[178:179], v250 offset:16896
    v_mfma_f32_32x32x16_bf16 v[80:95], v[188:191], v[136:139], v[80:95]
    ds_read_b64_tr_b16 v[180:181], v251 offset:16384
    ds_read_b64_tr_b16 v[182:183], v251 offset:16896
    buffer_load_dwordx4 v[120:123], v246, s[28:31], s78 offen offset:2048 sc1
    s_waitcnt vmcnt(11) lgkmcnt(4)
    v_mfma_f32_32x32x16_bf16 v[64:79], v[192:195], v[140:143], v[64:79]
    ds_read_b64_tr_b16 v[184:185], v250 offset:18432
    ds_read_b64_tr_b16 v[186:187], v250 offset:18944
    v_mfma_f32_32x32x16_bf16 v[80:95], v[196:199], v[140:143], v[80:95]
    ds_read_b64_tr_b16 v[188:189], v251 offset:18432
    ds_read_b64_tr_b16 v[190:191], v251 offset:18944
    buffer_load_dwordx4 v[124:127], v246, s[28:31], s78 offen offset:3072 sc1
    s_waitcnt vmcnt(11) lgkmcnt(4)
    v_mfma_f32_32x32x16_bf16 v[64:79], v[176:179], v[144:147], v[64:79]
    ds_read_b64_tr_b16 v[192:193], v250 offset:20480
    ds_read_b64_tr_b16 v[194:195], v250 offset:20992
    v_mfma_f32_32x32x16_bf16 v[80:95], v[180:183], v[144:147], v[80:95]
    ds_read_b64_tr_b16 v[196:197], v251 offset:20480
    ds_read_b64_tr_b16 v[198:199], v251 offset:20992
    s_mov_b32 s78, 36864
    buffer_load_dwordx4 v[128:131], v246, s[28:31], s78 offen offset:0 sc1
    s_waitcnt vmcnt(11) lgkmcnt(4)
    v_mfma_f32_32x32x16_bf16 v[64:79], v[184:187], v[148:151], v[64:79]
    ds_read_b64_tr_b16 v[176:177], v250 offset:22528
    ds_read_b64_tr_b16 v[178:179], v250 offset:23040
    v_mfma_f32_32x32x16_bf16 v[80:95], v[188:191], v[148:151], v[80:95]
    ds_read_b64_tr_b16 v[180:181], v251 offset:22528
    ds_read_b64_tr_b16 v[182:183], v251 offset:23040
    buffer_load_dwordx4 v[132:135], v246, s[28:31], s78 offen offset:1024 sc1
    s_barrier
    s_waitcnt vmcnt(11) lgkmcnt(4)
    v_mfma_f32_32x32x16_bf16 v[64:79], v[192:195], v[152:155], v[64:79]
    ds_read_b64_tr_b16 v[184:185], v250 offset:24576
    ds_read_b64_tr_b16 v[186:187], v250 offset:25088
    v_mfma_f32_32x32x16_bf16 v[80:95], v[196:199], v[152:155], v[80:95]
    ds_read_b64_tr_b16 v[188:189], v251 offset:24576
    ds_read_b64_tr_b16 v[190:191], v251 offset:25088
    buffer_load_dwordx4 v[136:139], v246, s[28:31], s78 offen offset:2048 sc1
    s_waitcnt vmcnt(11) lgkmcnt(4)
    v_mfma_f32_32x32x16_bf16 v[64:79], v[176:179], v[156:159], v[64:79]
    ds_read_b64_tr_b16 v[192:193], v250 offset:26624
    ds_read_b64_tr_b16 v[194:195], v250 offset:27136
    v_mfma_f32_32x32x16_bf16 v[80:95], v[180:183], v[156:159], v[80:95]
    ds_read_b64_tr_b16 v[196:197], v251 offset:26624
    ds_read_b64_tr_b16 v[198:199], v251 offset:27136
    buffer_load_dwordx4 v[140:143], v246, s[28:31], s78 offen offset:3072 sc1
    s_waitcnt vmcnt(11) lgkmcnt(4)
    v_mfma_f32_32x32x16_bf16 v[64:79], v[184:187], v[160:163], v[64:79]
    ds_read_b64_tr_b16 v[176:177], v250 offset:28672
    ds_read_b64_tr_b16 v[178:179], v250 offset:29184
    v_mfma_f32_32x32x16_bf16 v[80:95], v[188:191], v[160:163], v[80:95]
    ds_read_b64_tr_b16 v[180:181], v251 offset:28672
    ds_read_b64_tr_b16 v[182:183], v251 offset:29184
    s_mov_b32 s78, 40960
    buffer_load_dwordx4 v[144:147], v246, s[28:31], s78 offen offset:0 sc1
    s_waitcnt vmcnt(11) lgkmcnt(4)
    v_mfma_f32_32x32x16_bf16 v[64:79], v[192:195], v[164:167], v[64:79]
    ds_read_b64_tr_b16 v[184:185], v250 offset:30720
    ds_read_b64_tr_b16 v[186:187], v250 offset:31232
    v_mfma_f32_32x32x16_bf16 v[80:95], v[196:199], v[164:167], v[80:95]
    ds_read_b64_tr_b16 v[188:189], v251 offset:30720
    ds_read_b64_tr_b16 v[190:191], v251 offset:31232
    buffer_load_dwordx4 v[148:151], v246, s[28:31], s78 offen offset:1024 sc1
    s_waitcnt vmcnt(11) lgkmcnt(4)
    v_mfma_f32_32x32x16_bf16 v[64:79], v[176:179], v[168:171], v[64:79]
    ds_read_b64_tr_b16 v[192:193], v252 offset:0
    ds_read_b64_tr_b16 v[194:195], v252 offset:512
    v_lshlrev_b32 v96, 16, v16
    v_and_b32 v97, s81, v16
    v_lshlrev_b32 v98, 16, v17
    v_mfma_f32_32x32x16_bf16 v[80:95], v[180:183], v[168:171], v[80:95]
    ds_read_b64_tr_b16 v[196:197], v253 offset:0
    ds_read_b64_tr_b16 v[198:199], v253 offset:512
    v_and_b32 v99, s81, v17
    v_lshlrev_b32 v100, 16, v20
    v_and_b32 v101, s81, v20
    buffer_load_dwordx4 v[152:155], v246, s[28:31], s78 offen offset:2048 sc1
    s_waitcnt vmcnt(11) lgkmcnt(4)
    v_mfma_f32_32x32x16_bf16 v[64:79], v[184:187], v[172:175], v[64:79]
    ds_read_b64_tr_b16 v[176:177], v252 offset:2048
    ds_read_b64_tr_b16 v[178:179], v252 offset:2560
    v_lshlrev_b32 v102, 16, v21
    v_and_b32 v103, s81, v21
    v_lshlrev_b32 v104, 16, v18
    v_mfma_f32_32x32x16_bf16 v[80:95], v[188:191], v[172:175], v[80:95]
    ds_read_b64_tr_b16 v[180:181], v253 offset:2048
    ds_read_b64_tr_b16 v[182:183], v253 offset:2560
    v_and_b32 v105, s81, v18
    v_lshlrev_b32 v106, 16, v19
    v_and_b32 v107, s81, v19
    s_waitcnt vmcnt(10) lgkmcnt(4)
    v_mfma_f32_32x32x16_bf16 v[64:79], v[192:195], v[112:115], v[64:79]
    ds_read_b64_tr_b16 v[184:185], v252 offset:4096
    ds_read_b64_tr_b16 v[186:187], v252 offset:4608
    v_lshlrev_b32 v108, 16, v22
    v_and_b32 v109, s81, v22
    v_lshlrev_b32 v110, 16, v23
    v_mfma_f32_32x32x16_bf16 v[80:95], v[196:199], v[112:115], v[80:95]
    ds_read_b64_tr_b16 v[188:189], v253 offset:4096
    ds_read_b64_tr_b16 v[190:191], v253 offset:4608
    v_and_b32 v111, s81, v23
    s_waitcnt vmcnt(9) lgkmcnt(4)
    v_mfma_f32_32x32x16_bf16 v[64:79], v[176:179], v[116:119], v[64:79]
    ds_read_b64_tr_b16 v[192:193], v252 offset:6144
    ds_read_b64_tr_b16 v[194:195], v252 offset:6656
    v_mfma_f32_32x32x16_bf16 v[80:95], v[180:183], v[116:119], v[80:95]
    ds_read_b64_tr_b16 v[196:197], v253 offset:6144
    ds_read_b64_tr_b16 v[198:199], v253 offset:6656
    s_waitcnt vmcnt(8) lgkmcnt(4)
    v_mfma_f32_32x32x16_bf16 v[64:79], v[184:187], v[120:123], v[64:79]
    ds_read_b64_tr_b16 v[176:177], v252 offset:8192
    ds_read_b64_tr_b16 v[178:179], v252 offset:8704
    v_mfma_f32_32x32x16_bf16 v[80:95], v[188:191], v[120:123], v[80:95]
    ds_read_b64_tr_b16 v[180:181], v253 offset:8192
    ds_read_b64_tr_b16 v[182:183], v253 offset:8704
    s_waitcnt vmcnt(7) lgkmcnt(4)
    v_mfma_f32_32x32x16_bf16 v[64:79], v[192:195], v[124:127], v[64:79]
    ds_read_b64_tr_b16 v[184:185], v252 offset:10240
    ds_read_b64_tr_b16 v[186:187], v252 offset:10752
    v_mfma_f32_32x32x16_bf16 v[80:95], v[196:199], v[124:127], v[80:95]
    ds_read_b64_tr_b16 v[188:189], v253 offset:10240
    ds_read_b64_tr_b16 v[190:191], v253 offset:10752
    s_waitcnt vmcnt(6) lgkmcnt(4)
    v_mfma_f32_32x32x16_bf16 v[64:79], v[176:179], v[128:131], v[64:79]
    ds_read_b64_tr_b16 v[192:193], v252 offset:12288
    ds_read_b64_tr_b16 v[194:195], v252 offset:12800
    v_mfma_f32_32x32x16_bf16 v[80:95], v[180:183], v[128:131], v[80:95]
    ds_read_b64_tr_b16 v[196:197], v253 offset:12288
    ds_read_b64_tr_b16 v[198:199], v253 offset:12800
    s_waitcnt vmcnt(5) lgkmcnt(4)
    v_mfma_f32_32x32x16_bf16 v[64:79], v[184:187], v[132:135], v[64:79]
    ds_read_b64_tr_b16 v[176:177], v252 offset:14336
    ds_read_b64_tr_b16 v[178:179], v252 offset:14848
    v_mfma_f32_32x32x16_bf16 v[80:95], v[188:191], v[132:135], v[80:95]
    ds_read_b64_tr_b16 v[180:181], v253 offset:14336
    ds_read_b64_tr_b16 v[182:183], v253 offset:14848
    s_waitcnt vmcnt(4) lgkmcnt(4)
    v_mfma_f32_32x32x16_bf16 v[64:79], v[192:195], v[136:139], v[64:79]
    ds_read_b64_tr_b16 v[184:185], v248 offset:0
    ds_read_b64_tr_b16 v[186:187], v248 offset:512
    v_mfma_f32_32x32x16_bf16 v[80:95], v[196:199], v[136:139], v[80:95]
    ds_read_b64_tr_b16 v[188:189], v249 offset:0
    ds_read_b64_tr_b16 v[190:191], v249 offset:512
    s_waitcnt vmcnt(3) lgkmcnt(4)
    v_mfma_f32_32x32x16_bf16 v[64:79], v[176:179], v[140:143], v[64:79]
    ds_read_b64_tr_b16 v[192:193], v248 offset:2048
    ds_read_b64_tr_b16 v[194:195], v248 offset:2560
    v_mfma_f32_32x32x16_bf16 v[80:95], v[180:183], v[140:143], v[80:95]
    ds_read_b64_tr_b16 v[196:197], v249 offset:2048
    ds_read_b64_tr_b16 v[198:199], v249 offset:2560
    s_waitcnt vmcnt(2) lgkmcnt(4)
    v_mfma_f32_32x32x16_bf16 v[64:79], v[184:187], v[144:147], v[64:79]
    ds_read_b64_tr_b16 v[176:177], v248 offset:4096
    ds_read_b64_tr_b16 v[178:179], v248 offset:4608
    v_mfma_f32_32x32x16_bf16 v[80:95], v[188:191], v[144:147], v[80:95]
    ds_read_b64_tr_b16 v[180:181], v249 offset:4096
    ds_read_b64_tr_b16 v[182:183], v249 offset:4608
    s_waitcnt vmcnt(1) lgkmcnt(4)
    v_mfma_f32_32x32x16_bf16 v[64:79], v[192:195], v[148:151], v[64:79]
    v_mfma_f32_32x32x16_bf16 v[80:95], v[196:199], v[148:151], v[80:95]
    s_waitcnt vmcnt(0) lgkmcnt(0)
    v_mfma_f32_32x32x16_bf16 v[64:79], v[176:179], v[152:155], v[64:79]
    v_mfma_f32_32x32x16_bf16 v[80:95], v[180:183], v[152:155], v[80:95]
    s_nop 11
    ds_write_b128 v254, v[80:83] offset:0
    ds_write_b128 v254, v[84:87] offset:1024
    ds_write_b128 v254, v[88:91] offset:2048
    ds_write_b128 v254, v[92:95] offset:3072
    s_waitcnt lgkmcnt(0)
    s_barrier
    ds_read_b128 v[80:83], v255 offset:0
    ds_read_b128 v[84:87], v255 offset:1024
    ds_read_b128 v[88:91], v255 offset:2048
    ds_read_b128 v[92:95], v255 offset:3072
    s_waitcnt lgkmcnt(3)
    v_pk_add_f32 v[64:65], v[64:65], v[80:81]
    v_pk_add_f32 v[66:67], v[66:67], v[82:83]
    s_waitcnt lgkmcnt(2)
    v_pk_add_f32 v[68:69], v[68:69], v[84:85]
    v_pk_add_f32 v[70:71], v[70:71], v[86:87]
    s_waitcnt lgkmcnt(1)
    v_pk_add_f32 v[72:73], v[72:73], v[88:89]
    v_pk_add_f32 v[74:75], v[74:75], v[90:91]
    s_waitcnt lgkmcnt(0)
    s_nop 0
    v_pk_add_f32 v[76:77], v[76:77], v[92:93]
    v_pk_add_f32 v[78:79], v[78:79], v[94:95]
    v_pk_fma_f32 v[64:65], v[64:65], v[12:13], v[96:97] op_sel_hi:[1,0,1]
    v_pk_fma_f32 v[66:67], v[66:67], v[12:13], v[98:99] op_sel_hi:[1,0,1]
    v_pk_fma_f32 v[68:69], v[68:69], v[12:13], v[100:101] op_sel_hi:[1,0,1]
    v_pk_fma_f32 v[70:71], v[70:71], v[12:13], v[102:103] op_sel_hi:[1,0,1]
    v_pk_fma_f32 v[72:73], v[72:73], v[12:13], v[104:105] op_sel_hi:[1,0,1]
    v_pk_fma_f32 v[74:75], v[74:75], v[12:13], v[106:107] op_sel_hi:[1,0,1]
    v_pk_fma_f32 v[76:77], v[76:77], v[12:13], v[108:109] op_sel_hi:[1,0,1]
    v_pk_fma_f32 v[78:79], v[78:79], v[12:13], v[110:111] op_sel_hi:[1,0,1]
    v_cvt_pk_bf16_f32 v48, v64, v65
    v_cvt_pk_bf16_f32 v49, v66, v67
    v_cvt_pk_bf16_f32 v50, v68, v69
    v_cvt_pk_bf16_f32 v51, v70, v71
    buffer_store_dwordx4 v[48:51], v245, s[24:27], 0 offen
    v_cvt_pk_bf16_f32 v52, v72, v73
    v_cvt_pk_bf16_f32 v53, v74, v75
    v_cvt_pk_bf16_f32 v54, v76, v77
    v_cvt_pk_bf16_f32 v55, v78, v79
    buffer_store_dwordx4 v[52:55], v245, s[24:27], 0 offen offset:32
Lend:
    s_endpgm
Lloader:
    s_getpc_b64 s[60:61]
CODE_PC:
    s_sub_u32 s60, s60, CODE_PC-CODE_BEGIN
    s_subb_u32 s61, s61, 0
    s_lshr_b32 s59, s2, 3
    s_and_b32 s59, s59, 7
    s_lshl_b32 s59, s59, 2
    s_add_u32 s59, s59, s56
    s_lshl_b32 s59, s59, 10
    v_lshl_add_u32 v2, v1, 4, s59
    v_min_u32 v2, CODE_END-CODE_BEGIN-16, v2
    global_load_dwordx4 v[20:23], v2, s[60:61]
    s_mov_b32 s6, 0x200000
    s_mov_b32 s7, 0x20000
    s_mov_b32 s10, 0x80000
    s_mov_b32 s11, 0x20000
    s_mov_b32 s14, 0x80000
    s_mov_b32 s15, 0x20000
    s_mov_b32 s18, 0x158800
    s_mov_b32 s19, 0x20000
    s_mov_b32 s22, 0x158000
    s_mov_b32 s23, 0x20000
    s_mov_b32 s26, 0x200000
    s_mov_b32 s27, 0x20000
    s_mov_b32 s30, 0xc00000
    s_mov_b32 s31, 0x20000
    v_lshrrev_b32 v40, 3, v1
    v_and_b32 v41, 7, v1
    v_bfe_u32 v42, v1, 4, 1
    v_lshlrev_b32 v42, 1, v42
    v_xor_b32 v41, v41, v42
    s_xor_b32 s60, s55, 0
    s_lshl_b32 s60, s60, 7
    v_lshlrev_b32 v40, 10, v40
    v_add_u32 v40, s60, v40
    v_lshl_add_u32 v4, v41, 4, v40
    v_xor_b32_e64 v41, 4, v41
    v_lshl_add_u32 v5, v41, 4, v40
    v_add_u32 v6, 14336, v4
    v_add_u32 v7, 21504, v5
    v_add_u32 v5, 7168, v5
    s_lshl_b32 s67, s56, 15
    s_lshl_b32 s68, s56, 12
    v_lshrrev_b32 v40, 3, v1
    v_and_b32 v41, 7, v1
    v_and_b32 v42, 6, v40
    v_xor_b32 v41, v41, v42
    s_xor_b32 s60, s55, 0
    s_lshl_b32 s60, s60, 7
    v_lshlrev_b32 v40, 10, v40
    v_add_u32 v40, s60, v40
    v_lshl_add_u32 v8, v41, 4, v40
    v_add_u32 v9, 7168, v8
    v_add_u32 v10, 14336, v8
    v_add_u32 v11, 21504, v8
    s_lshl_b32 s3, s56, 17
    s_lshl_b32 s65, s56, 14
    s_add_u32 s65, s65, 65536
    s_waitcnt lgkmcnt(0)
    s_mov_b32 s4, s36
    s_mov_b32 s5, s37
    s_mov_b32 s8, s38
    s_mov_b32 s9, s39
    s_mov_b32 s12, s40
    s_mov_b32 s13, s41
    s_sub_u32 s16, s42, 2048
    s_subb_u32 s17, s43, 0
    s_mov_b32 s20, s44
    s_mov_b32 s21, s45
    s_mov_b32 s24, s46
    s_mov_b32 s25, s47
    s_mov_b32 s28, s50
    s_mov_b32 s29, s51
    s_mov_b32 s57, 0
    v_lshrrev_b32 v40, 2, v1
    v_and_b32 v41, 7, v40
    v_lshrrev_b32 v40, 3, v40
    v_lshl_add_u32 v40, v40, 4, v41
    v_mul_u32_u24 v40, 2752, v40
    v_and_b32_e64 v41, 3, v1
    v_lshl_add_u32 v40, v41, 4, v40
    v_add_u32 v12, 2048, v40
    v_add_u32 v13, 1088, v40
    v_add_u32 v14, 128, v40
    s_lshr_b32 s59, s56, 1
    s_lshl_b32 s59, s59, 5
    s_and_b32 s60, s56, 1
    s_lshl_b32 s60, s60, 3
    s_add_u32 s59, s59, s60
    s_mul_i32 s59, s59, 2752
    s_lshl_b32 s60, s58, 6
    s_add_u32 s36, s59, s60
    s_mul_i32 s37, s56, 3072
    v_lshrrev_b32 v40, 3, v1
    v_and_b32 v41, 7, v1
    v_bfe_u32 v42, v1, 4, 1
    v_lshlrev_b32 v42, 2, v42
    v_xor_b32 v41, v41, v42
    s_xor_b32 s60, s55, 0
    s_lshl_b32 s60, s60, 7
    v_lshlrev_b32 v40, 10, v40
    v_add_u32_e64 v40, s60, v40
    v_lshl_add_u32 v16, v41, 4, v40
    v_add_u32 v17, 7168, v16
    v_add_u32 v18, 14336, v16
    v_add_u32 v19, 21504, v16
    s_lshr_b32 s38, s56, 1
    s_and_b32 s39, s56, 1
    s_mul_i32 s40, s38, 704512
    s_add_u32 m0, s68, 0
    s_add_u32 s59, s69, 0
    s_and_b32 s59, s59, 3
    s_lshl_b32 s59, s59, 17
    s_add_u32 s79, s59, s67
    buffer_load_dwordx4 v4, s[8:11], s79 offen offset:0 lds
    buffer_load_dwordx4 v5, s[8:11], s79 offen offset:1024 lds
    buffer_load_dwordx4 v6, s[8:11], s79 offen offset:2048 lds
    buffer_load_dwordx4 v7, s[8:11], s79 offen offset:3072 lds
    s_add_u32 m0, s68, 16384
    s_add_u32 s59, s69, 1
    s_and_b32 s59, s59, 3
    s_lshl_b32 s59, s59, 17
    s_add_u32 s79, s59, s67
    buffer_load_dwordx4 v4, s[8:11], s79 offen offset:0 lds
    buffer_load_dwordx4 v5, s[8:11], s79 offen offset:1024 lds
    buffer_load_dwordx4 v6, s[8:11], s79 offen offset:2048 lds
    buffer_load_dwordx4 v7, s[8:11], s79 offen offset:3072 lds
    v_lshrrev_b32 v24, 3, v1
    v_lshlrev_b32 v24, 10, v24
    v_and_b32 v25, 7, v1
    v_lshl_add_u32 v24, v25, 4, v24
    s_lshl_b32 s59, s54, 16
    s_lshl_b32 s60, s55, 7
    s_add_u32 s59, s59, s60
    s_lshl_b32 s60, s56, 14
    s_add_u32 s59, s59, s60
    v_add_u32 v24, s59, v24
    v_add_u32 v26, 7168, v24
    s_lshl_b32 s60, s56, 11
    s_add_u32 m0, s60, 155648
    s_nop 0
    buffer_load_dwordx4 v24, s[4:7], 0 offen lds
    buffer_load_dwordx4 v26, s[4:7], 0 offen offset:1024 lds
    s_add_u32 m0, s68, 32768
    s_add_u32 s59, s69, 2
    s_and_b32 s59, s59, 3
    s_lshl_b32 s59, s59, 17
    s_add_u32 s79, s59, s67
    buffer_load_dwordx4 v4, s[8:11], s79 offen offset:0 lds
    buffer_load_dwordx4 v5, s[8:11], s79 offen offset:1024 lds
    buffer_load_dwordx4 v6, s[8:11], s79 offen offset:2048 lds
    buffer_load_dwordx4 v7, s[8:11], s79 offen offset:3072 lds
    s_add_u32 m0, s68, 49152
    s_add_u32 s59, s69, 3
    s_and_b32 s59, s59, 3
    s_lshl_b32 s59, s59, 17
    s_add_u32 s79, s59, s67
    buffer_load_dwordx4 v4, s[8:11], s79 offen offset:0 lds
    buffer_load_dwordx4 v5, s[8:11], s79 offen offset:1024 lds
    buffer_load_dwordx4 v6, s[8:11], s79 offen offset:2048 lds
    buffer_load_dwordx4 v7, s[8:11], s79 offen offset:3072 lds
    s_waitcnt vmcnt(14)
    s_barrier
    s_mul_i32 s59, s2, 5504
    s_mul_i32 s60, s56, 1408
    s_add_u32 s59, s59, s60
    s_add_u32 s59, s59, 2048
    v_min_u32 v24, 10, v1
    v_lshl_add_u32 v24, v24, 7, s59
    buffer_load_dword v25, v24, s[16:19], 0 offen
    s_mul_i32 s59, s2, 5504
    s_mul_i32 s60, s56, 1408
    s_add_u32 s59, s59, s60
    v_min_u32 v24, 10, v1
    v_lshl_add_u32 v24, v24, 7, s59
    buffer_load_dword v25, v24, s[20:23], 0 offen
    s_waitcnt vmcnt(12)
    s_barrier
    s_add_u32 m0, s65, 0
    s_add_u32 s59, s69, 0
    s_and_b32 s59, s59, 3
    s_lshl_b32 s59, s59, 15
    s_add_u32 s79, s59, s3
    buffer_load_dwordx4 v8, s[12:15], s79 offen offset:0 lds
    buffer_load_dwordx4 v9, s[12:15], s79 offen offset:1024 lds
    buffer_load_dwordx4 v10, s[12:15], s79 offen offset:2048 lds
    buffer_load_dwordx4 v11, s[12:15], s79 offen offset:3072 lds
    s_waitcnt vmcnt(10)
    s_barrier
    s_add_u32 m0, s65, 4096
    s_add_u32 s59, s69, 1
    s_and_b32 s59, s59, 3
    s_lshl_b32 s59, s59, 15
    s_add_u32 s79, s59, s3
    buffer_load_dwordx4 v8, s[12:15], s79 offen offset:0 lds
    buffer_load_dwordx4 v9, s[12:15], s79 offen offset:1024 lds
    buffer_load_dwordx4 v10, s[12:15], s79 offen offset:2048 lds
    buffer_load_dwordx4 v11, s[12:15], s79 offen offset:3072 lds
    s_waitcnt vmcnt(10)
    s_barrier
    s_add_u32 m0, s65, 8192
    s_add_u32 s59, s69, 2
    s_and_b32 s59, s59, 3
    s_lshl_b32 s59, s59, 15
    s_add_u32 s79, s59, s3
    buffer_load_dwordx4 v8, s[12:15], s79 offen offset:0 lds
    buffer_load_dwordx4 v9, s[12:15], s79 offen offset:1024 lds
    buffer_load_dwordx4 v10, s[12:15], s79 offen offset:2048 lds
    buffer_load_dwordx4 v11, s[12:15], s79 offen offset:3072 lds
    s_barrier
    s_add_u32 m0, s65, 12288
    s_add_u32 s59, s69, 3
    s_and_b32 s59, s59, 3
    s_lshl_b32 s59, s59, 15
    s_add_u32 s79, s59, s3
    buffer_load_dwordx4 v8, s[12:15], s79 offen offset:0 lds
    buffer_load_dwordx4 v9, s[12:15], s79 offen offset:1024 lds
    buffer_load_dwordx4 v10, s[12:15], s79 offen offset:2048 lds
    buffer_load_dwordx4 v11, s[12:15], s79 offen offset:3072 lds
    s_and_b32 s72, s52, 1
    s_mul_i32 s72, s72, 3
    s_add_u32 s60, s72, 0
    s_cmp_ge_u32 s60, 6
    s_cselect_b32 s59, 6, 0
    s_sub_u32 s60, s60, s59
    s_cmp_lt_u32 s60, 2
    s_cselect_b32 s59, 155648, 0
    s_mul_i32 s61, s60, 12288
    s_add_u32 s61, s61, s37
    s_add_u32 s61, s61, s59
    s_sub_u32 s61, s61, 24576
    s_mov_b32 m0, s61
    s_mul_i32 s60, s60, 176128
    s_add_u32 s79, s60, s36
    buffer_load_dwordx4 v12, s[16:19], s79 offen offset:0 lds
    buffer_load_dwordx4 v13, s[16:19], s79 offen offset:1024 lds
    buffer_load_dwordx4 v14, s[16:19], s79 offen offset:2048 lds
    s_add_u32 s60, s72, 1
    s_cmp_ge_u32 s60, 6
    s_cselect_b32 s59, 6, 0
    s_sub_u32 s60, s60, s59
    s_cmp_lt_u32 s60, 2
    s_cselect_b32 s59, 155648, 0
    s_mul_i32 s61, s60, 12288
    s_add_u32 s61, s61, s37
    s_add_u32 s61, s61, s59
    s_sub_u32 s61, s61, 24576
    s_mov_b32 m0, s61
    s_mul_i32 s60, s60, 176128
    s_add_u32 s79, s60, s36
    buffer_load_dwordx4 v12, s[16:19], s79 offen offset:0 lds
    buffer_load_dwordx4 v13, s[16:19], s79 offen offset:1024 lds
    s_waitcnt vmcnt(4)
    buffer_load_dwordx4 v14, s[16:19], s79 offen offset:2048 lds
    s_waitcnt vmcnt(4)
    s_add_u32 s60, s72, 2
    s_cmp_ge_u32 s60, 6
    s_cselect_b32 s59, 6, 0
    s_sub_u32 s60, s60, s59
    s_cmp_lt_u32 s60, 2
    s_cselect_b32 s59, 155648, 0
    s_mul_i32 s61, s60, 12288
    s_add_u32 s61, s61, s37
    s_add_u32 s61, s61, s59
    s_sub_u32 s61, s61, 24576
    s_mov_b32 m0, s61
    s_mul_i32 s60, s60, 176128
    s_add_u32 s79, s60, s36
    buffer_load_dwordx4 v12, s[16:19], s79 offen offset:0 lds
    s_waitcnt vmcnt(4)
    buffer_load_dwordx4 v13, s[16:19], s79 offen offset:1024 lds
    s_waitcnt vmcnt(4)
    buffer_load_dwordx4 v14, s[16:19], s79 offen offset:2048 lds
    s_waitcnt vmcnt(4)
    s_add_u32 s60, s72, 3
    s_cmp_ge_u32 s60, 6
    s_cselect_b32 s59, 6, 0
    s_sub_u32 s60, s60, s59
    s_cmp_lt_u32 s60, 2
    s_cselect_b32 s59, 155648, 0
    s_mul_i32 s61, s60, 12288
    s_add_u32 s61, s61, s37
    s_add_u32 s61, s61, s59
    s_sub_u32 s61, s61, 24576
    s_mov_b32 m0, s61
    s_mul_i32 s60, s60, 176128
    s_add_u32 s79, s60, s36
    buffer_load_dwordx4 v12, s[16:19], s79 offen offset:0 lds
    s_waitcnt vmcnt(4)
    buffer_load_dwordx4 v13, s[16:19], s79 offen offset:1024 lds
    s_waitcnt vmcnt(4)
    buffer_load_dwordx4 v14, s[16:19], s79 offen offset:2048 lds
    s_waitcnt vmcnt(4)
    s_add_u32 s60, s72, 4
    s_cmp_ge_u32 s60, 6
    s_cselect_b32 s59, 6, 0
    s_sub_u32 s60, s60, s59
    s_cmp_lt_u32 s60, 2
    s_cselect_b32 s59, 155648, 0
    s_mul_i32 s61, s60, 12288
    s_add_u32 s61, s61, s37
    s_add_u32 s61, s61, s59
    s_sub_u32 s61, s61, 24576
    s_mov_b32 m0, s61
    s_mul_i32 s60, s60, 176128
    s_add_u32 s79, s60, s36
    buffer_load_dwordx4 v12, s[16:19], s79 offen offset:0 lds
    s_waitcnt vmcnt(4)
    buffer_load_dwordx4 v13, s[16:19], s79 offen offset:1024 lds
    s_waitcnt vmcnt(4)
    buffer_load_dwordx4 v14, s[16:19], s79 offen offset:2048 lds
    s_waitcnt vmcnt(4)
    s_add_u32 s60, s72, 5
    s_cmp_ge_u32 s60, 6
    s_cselect_b32 s59, 6, 0
    s_sub_u32 s60, s60, s59
    s_cmp_lt_u32 s60, 2
    s_cselect_b32 s59, 155648, 0
    s_mul_i32 s61, s60, 12288
    s_add_u32 s61, s61, s37
    s_add_u32 s61, s61, s59
    s_sub_u32 s61, s61, 24576
    s_mov_b32 m0, s61
    s_mul_i32 s60, s60, 176128
    s_add_u32 s79, s60, s36
    buffer_load_dwordx4 v12, s[16:19], s79 offen offset:0 lds
    s_waitcnt vmcnt(4)
    buffer_load_dwordx4 v13, s[16:19], s79 offen offset:1024 lds
    s_waitcnt vmcnt(4)
    buffer_load_dwordx4 v14, s[16:19], s79 offen offset:2048 lds
    s_waitcnt vmcnt(4)
    s_waitcnt vmcnt(0)
    s_barrier
    s_barrier
    s_add_u32 m0, s37, 49152
    s_add_u32 s79, s36, 1056768
    buffer_load_dwordx4 v12, s[16:19], s79 offen offset:0 lds
    buffer_load_dwordx4 v13, s[16:19], s79 offen offset:1024 lds
    buffer_load_dwordx4 v14, s[16:19], s79 offen offset:2048 lds
    s_add_u32 s59, s37, 152576
    s_cmp_eq_u32 s56, 0
    s_cselect_b32 m0, 61440, s59
    s_add_u32 s79, s36, 1232896
    buffer_load_dwordx4 v12, s[16:19], s79 offen offset:0 lds
    buffer_load_dwordx4 v13, s[16:19], s79 offen offset:1024 lds
    s_waitcnt vmcnt(4)
    s_add_u32 s59, s37, 152576
    s_cmp_eq_u32 s56, 3
    s_cselect_b32 s59, 62464, s59
    s_cmp_eq_u32 s56, 0
    s_cselect_b32 m0, 61440, s59
    s_add_u32 s79, s36, 1232896
    buffer_load_dwordx4 v14, s[16:19], s79 offen offset:2048 lds
    s_waitcnt vmcnt(4)
    s_mul_i32 s61, s39, 131072
    s_add_u32 s61, s61, s40
    s_mul_i32 s62, s39, 16384
    s_mul_i32 s59, s38, 32768
    s_add_u32 s62, s62, s59
    s_waitcnt vmcnt(0)
    s_barrier
    s_cmp_eq_u32 s69, 3
    s_cselect_b32 s59, 0, s69
    s_add_u32 s59, s59, 0
    s_cmp_ge_u32 s59, 3
    s_cselect_b32 s60, 3, 0
    s_sub_u32 s59, s59, s60
    s_lshl_b32 s60, s59, 12
    s_add_u32 s60, s60, s62
    s_add_u32 m0, s60, 65536
    s_lshl_b32 s59, s59, 15
    s_add_u32 s79, s59, s61
    buffer_load_dwordx4 v16, s[20:23], s79 offen offset:0 lds
    buffer_load_dwordx4 v17, s[20:23], s79 offen offset:1024 lds
    buffer_load_dwordx4 v18, s[20:23], s79 offen offset:2048 lds
    buffer_load_dwordx4 v19, s[20:23], s79 offen offset:3072 lds
    s_cmp_eq_u32 s69, 3
    s_cselect_b32 s59, 0, s69
    s_add_u32 s59, s59, 1
    s_cmp_ge_u32 s59, 3
    s_cselect_b32 s60, 3, 0
    s_sub_u32 s59, s59, s60
    s_lshl_b32 s60, s59, 12
    s_add_u32 s60, s60, s62
    s_add_u32 m0, s60, 65536
    s_lshl_b32 s59, s59, 15
    s_add_u32 s79, s59, s61
    buffer_load_dwordx4 v16, s[20:23], s79 offen offset:0 lds
    buffer_load_dwordx4 v17, s[20:23], s79 offen offset:1024 lds
    buffer_load_dwordx4 v18, s[20:23], s79 offen offset:2048 lds
    buffer_load_dwordx4 v19, s[20:23], s79 offen offset:3072 lds
    s_cmp_eq_u32 s69, 3
    s_cselect_b32 s59, 0, s69
    s_add_u32 s59, s59, 2
    s_cmp_ge_u32 s59, 3
    s_cselect_b32 s60, 3, 0
    s_sub_u32 s59, s59, s60
    s_lshl_b32 s60, s59, 12
    s_add_u32 s60, s60, s62
    s_add_u32 m0, s60, 65536
    s_lshl_b32 s59, s59, 15
    s_add_u32 s79, s59, s61
    buffer_load_dwordx4 v16, s[20:23], s79 offen offset:0 lds
    buffer_load_dwordx4 v17, s[20:23], s79 offen offset:1024 lds
    buffer_load_dwordx4 v18, s[20:23], s79 offen offset:2048 lds
    buffer_load_dwordx4 v19, s[20:23], s79 offen offset:3072 lds
    s_barrier
    s_barrier
    s_mov_b32 s59, 3
    s_lshl_b32 s60, s59, 12
    s_add_u32 s60, s60, s62
    s_add_u32 m0, s60, 65536
    s_lshl_b32 s59, s59, 15
    s_add_u32 s79, s59, s61
    buffer_load_dwordx4 v16, s[20:23], s79 offen offset:0 lds
    buffer_load_dwordx4 v17, s[20:23], s79 offen offset:1024 lds
    buffer_load_dwordx4 v18, s[20:23], s79 offen offset:2048 lds
    buffer_load_dwordx4 v19, s[20:23], s79 offen offset:3072 lds
    s_barrier
    s_mul_i32 s61, s39, 131072
    s_add_u32 s61, s61, s40
    s_mul_i32 s62, s39, 16384
    s_mul_i32 s59, s38, 32768
    s_add_u32 s62, s62, s59
    s_add_u32 s59, s69, 0
    s_and_b32 s59, s59, 3
    s_lshl_b32 s60, s59, 12
    s_add_u32 s60, s60, s62
    s_add_u32 m0, s60, 0
    s_lshl_b32 s59, s59, 15
    s_add_u32 s59, s59, s61
    s_add_u32 s79, s59, 262144
    buffer_load_dwordx4 v16, s[20:23], s79 offen offset:0 lds
    s_waitcnt vmcnt(4)
    buffer_load_dwordx4 v17, s[20:23], s79 offen offset:1024 lds
    s_waitcnt vmcnt(4)
    buffer_load_dwordx4 v18, s[20:23], s79 offen offset:2048 lds
    s_waitcnt vmcnt(4)
    buffer_load_dwordx4 v19, s[20:23], s79 offen offset:3072 lds
    s_waitcnt vmcnt(4)
    s_add_u32 s59, s69, 1
    s_and_b32 s59, s59, 3
    s_lshl_b32 s60, s59, 12
    s_add_u32 s60, s60, s62
    s_add_u32 m0, s60, 0
    s_lshl_b32 s59, s59, 15
    s_add_u32 s59, s59, s61
    s_add_u32 s79, s59, 262144
    buffer_load_dwordx4 v16, s[20:23], s79 offen offset:0 lds
    s_waitcnt vmcnt(4)
    buffer_load_dwordx4 v17, s[20:23], s79 offen offset:1024 lds
    s_waitcnt vmcnt(4)
    buffer_load_dwordx4 v18, s[20:23], s79 offen offset:2048 lds
    s_waitcnt vmcnt(4)
    buffer_load_dwordx4 v19, s[20:23], s79 offen offset:3072 lds
    s_waitcnt vmcnt(4)
    s_add_u32 s59, s69, 2
    s_and_b32 s59, s59, 3
    s_lshl_b32 s60, s59, 12
    s_add_u32 s60, s60, s62
    s_add_u32 m0, s60, 0
    s_lshl_b32 s59, s59, 15
    s_add_u32 s59, s59, s61
    s_add_u32 s79, s59, 262144
    buffer_load_dwordx4 v16, s[20:23], s79 offen offset:0 lds
    s_waitcnt vmcnt(4)
    buffer_load_dwordx4 v17, s[20:23], s79 offen offset:1024 lds
    s_waitcnt vmcnt(4)
    buffer_load_dwordx4 v18, s[20:23], s79 offen offset:2048 lds
    s_waitcnt vmcnt(4)
    buffer_load_dwordx4 v19, s[20:23], s79 offen offset:3072 lds
    s_waitcnt vmcnt(4)
    s_add_u32 s59, s69, 3
    s_and_b32 s59, s59, 3
    s_lshl_b32 s60, s59, 12
    s_add_u32 s60, s60, s62
    s_add_u32 m0, s60, 0
    s_lshl_b32 s59, s59, 15
    s_add_u32 s59, s59, s61
    s_add_u32 s79, s59, 262144
    buffer_load_dwordx4 v16, s[20:23], s79 offen offset:0 lds
    s_waitcnt vmcnt(4)
    buffer_load_dwordx4 v17, s[20:23], s79 offen offset:1024 lds
    s_waitcnt vmcnt(4)
    buffer_load_dwordx4 v18, s[20:23], s79 offen offset:2048 lds
    s_waitcnt vmcnt(4)
    buffer_load_dwordx4 v19, s[20:23], s79 offen offset:3072 lds
    s_waitcnt vmcnt(4)
    s_mul_i32 s61, s39, 65536
    s_add_u32 s61, s61, s40
    s_mul_i32 s62, s39, 8192
    s_mul_i32 s59, s38, 16384
    s_add_u32 s62, s62, s59
    s_add_u32 s59, s69, 0
    s_and_b32 s59, s59, 1
    s_lshl_b32 s60, s59, 12
    s_add_u32 s60, s60, s62
    s_add_u32 m0, s60, 131072
    s_lshl_b32 s59, s59, 15
    s_add_u32 s59, s59, s61
    s_add_u32 s79, s59, 524288
    buffer_load_dwordx4 v16, s[20:23], s79 offen offset:0 lds
    s_waitcnt vmcnt(4)
    buffer_load_dwordx4 v17, s[20:23], s79 offen offset:1024 lds
    s_waitcnt vmcnt(4)
    buffer_load_dwordx4 v18, s[20:23], s79 offen offset:2048 lds
    s_waitcnt vmcnt(4)
    buffer_load_dwordx4 v19, s[20:23], s79 offen offset:3072 lds
    s_waitcnt vmcnt(4)
    s_add_u32 s59, s69, 1
    s_and_b32 s59, s59, 1
    s_lshl_b32 s60, s59, 12
    s_add_u32 s60, s60, s62
    s_add_u32 m0, s60, 131072
    s_lshl_b32 s59, s59, 15
    s_add_u32 s59, s59, s61
    s_add_u32 s79, s59, 524288
    buffer_load_dwordx4 v16, s[20:23], s79 offen offset:0 lds
    s_waitcnt vmcnt(4)
    buffer_load_dwordx4 v17, s[20:23], s79 offen offset:1024 lds
    s_waitcnt vmcnt(4)
    buffer_load_dwordx4 v18, s[20:23], s79 offen offset:2048 lds
    s_waitcnt vmcnt(4)
    buffer_load_dwordx4 v19, s[20:23], s79 offen offset:3072 lds
    s_waitcnt vmcnt(4)
    s_barrier
    s_waitcnt vmcnt(0)
    s_barrier
    s_mul_i32 s61, s39, 24576
    s_add_u32 s61, s61, s40
    s_mul_i32 s62, s39, 3072
    s_mul_i32 s59, s38, 32768
    s_add_u32 s62, s62, s59
    s_add_u32 m0, s62, 65536
    s_add_u32 s79, s61, 655360
    buffer_load_dwordx4 v16, s[20:23], s79 offen offset:0 lds
    buffer_load_dwordx4 v17, s[20:23], s79 offen offset:1024 lds
    buffer_load_dwordx4 v18, s[20:23], s79 offen offset:2048 lds
    s_waitcnt vmcnt(0)
    s_barrier
    s_endpgm
CODE_END:
.section .rodata,"a"
.p2align 6
.amdhsa_kernel standalone__mixer_s_mlp__prompt_kernel
  .amdhsa_next_free_vgpr 256
  .amdhsa_next_free_sgpr 102
  .amdhsa_accum_offset 256
  .amdhsa_group_segment_fixed_size 0
  .amdhsa_kernarg_size 64
  .amdhsa_user_sgpr_count 2
  .amdhsa_user_sgpr_kernarg_segment_ptr 1
  .amdhsa_system_sgpr_workgroup_id_x 1
  .amdhsa_float_denorm_mode_32 3
.end_amdhsa_kernel
```
